```python
import torch

def _softmax(x, axis=-1):
    return torch.softmax(x, dim=axis)

def _gelu(x):
    return torch.nn.functional.gelu(x, approximate='tanh')

def _silu(x):
    return torch.nn.functional.silu(x)

def _sigmoid(x):
    return torch.sigmoid(x)

def _layernorm(x, axis=-1, eps=1e-05):
    m = x.mean(dim=axis, keepdim=True)
    v = x.var(dim=axis, keepdim=True, unbiased=False)
    return (x - m) / torch.sqrt(v + eps)

def _scatter_add(tgt, idx, src, axis=0):
    return tgt.clone().index_add_(axis, idx, src)

def _segment_sum(src, seg, n):
    out = torch.zeros((n,) + src.shape[1:], dtype=src.dtype)
    return out.index_add_(0, seg, src)

def _pad(x, pw):
    flat = tuple((v for pair in reversed(pw) for v in pair))
    return torch.nn.functional.pad(x, flat)
kernel_name = 'adaLN_cond__ssm_conv_h3__geglu_ffn__prompt'

def setup_inputs():

    _w = lambda a: (lambda t: t.to(torch.bfloat16) if t.is_floating_point() else t)(torch.as_tensor(a))

    def _A_setup():
        B, S, D = (1, 2048, 512)
        ks = 4
        return {'q': _w((lambda *s: torch.randn(*s, dtype=torch.bfloat16) * 0.05)(B, S, D)), 'k': _w((lambda *s: torch.randn(*s, dtype=torch.bfloat16) * 0.8)(B, S, D)), 'v': _w((lambda *s: torch.randn(*s, dtype=torch.bfloat16) * 0.8)(B, S, D)), 'shift_k': _w((lambda *s: torch.randn(*s, dtype=torch.bfloat16) * 0.8)(D, ks) * 0.5), 'ssm_k': _w((lambda *s: torch.randn(*s, dtype=torch.bfloat16) * 0.8)(D, S) * (1.0 / S ** 0.5)), 'ssm_D': _w((lambda *s: torch.randn(*s, dtype=torch.bfloat16) * 0.8)(D))}
    _A_in = _A_setup()

    def _B_setup():
        B, S, D, F = (1, 2048, 512, 1792)
        return {'x': _w((lambda *s: torch.randn(*s, dtype=torch.bfloat16) * 0.05)(B, S, D)), 'w_gate': _w((lambda *s: torch.randn(*s, dtype=torch.bfloat16) * 0.05)(D, F)), 'w_up': _w((lambda *s: torch.randn(*s, dtype=torch.bfloat16) * 0.05)(D, F)), 'w_down': _w((lambda *s: torch.randn(*s, dtype=torch.bfloat16) * 0.05)(F, D))}
    _B_in = _B_setup()
    return {'A_q': _A_in['q'], 'A_k': _A_in['k'], 'A_v': _A_in['v'], 'A_shift_k': _A_in['shift_k'], 'A_ssm_k': _A_in['ssm_k'], 'A_ssm_D': _A_in['ssm_D'], 'B_x': _B_in['x'], 'B_w_gate': _B_in['w_gate'], 'B_w_up': _B_in['w_up'], 'B_w_down': _B_in['w_down'], 'c': _w((lambda *s: torch.randn(*s, dtype=torch.bfloat16) * 0.1)(1, 512) * 8.0), 'w_mod': _w((lambda *s: torch.randn(*s, dtype=torch.bfloat16) * 0.1)(512, 6 * 512) * 512 ** (-0.5) * 8.0)}

def reference(A_q, A_k, A_v, A_shift_k, A_ssm_k, A_ssm_D, B_x, B_w_gate, B_w_up, B_w_down, c, w_mod):

    def _A_ref(q, k, v, shift_k, ssm_k, ssm_D):
        B, S, D = q.shape
        ks = shift_k.shape[-1]
        k_pad = _pad(k, ((0, 0), (ks - 1, 0), (0, 0)))
        k_shift = torch.zeros_like(k)
        for t in range(ks):
            k_shift = k_shift + k_pad[:, t:t + S, :] * shift_k[:, ks - 1 - t][None, None, :]
        kv = k_shift * v
        L = 2 * S
        kv_pad = _pad(kv, ((0, 0), (0, S), (0, 0)))
        kf_pad = _pad(ssm_k, ((0, 0), (0, S)))
        kv_f = (lambda x, axes=(-2, -1): torch.fft.rfft2(x.float(), dim=axes))(kv_pad[:, None, :, :], axes=(1, 2))
        kf_f = (lambda x, axes=(-2, -1): torch.fft.rfft2(x.float(), dim=axes))(kf_pad[:, None, :], axes=(1, 2))
        kf_f = (lambda x, *d: x.permute(*d))(kf_f, 1, 2, 0)
        y_f = kv_f * kf_f[None, :, :, :]
        y = (lambda x, s, axes=(-2, -1): torch.fft.irfft2(x, s=s, dim=axes).to(torch.bfloat16))(y_f, (1, L), axes=(1, 2))[:, 0, :S, :]
        y = y + kv * ssm_D[None, None, :]
        return q * y

    def _B_ref(x, w_gate, w_up, w_down):
        return _gelu(x @ w_gate) * (x @ w_up) @ w_down
    x = A_q
    mod = (_silu(c) @ w_mod).reshape(c.shape[0], 6, 1, -1)
    sa, ca, ga, sb, cb, gb = (mod[:, 0].clone(), mod[:, 1].clone(), mod[:, 2].clone(), mod[:, 3].clone(), mod[:, 4].clone(), mod[:, 5].clone())
    h = _layernorm(x, axis=-1) * (1 + ca) + sa
    x = x + ga * _A_ref(h, A_k, A_v, A_shift_k, A_ssm_k, A_ssm_D)
    h = _layernorm(x, axis=-1) * (1 + cb) + sb
    x = x + gb * _B_ref(h, B_w_gate, B_w_up, B_w_down)
    return x
```

```asm
; @launch grid=(256,1,1) block=(256,1,1) lds=163840
.amdgcn_target "amdgcn-amd-amdhsa--gfx950"
.text
.globl adaLN_cond__ssm_conv_h3__geglu_ffn__prompt_kernel
.p2align 8
.type adaLN_cond__ssm_conv_h3__geglu_ffn__prompt_kernel,@function
adaLN_cond__ssm_conv_h3__geglu_ffn__prompt_kernel:
    s_cmp_ge_u32 s2, 256
    s_cbranch_scc1 L_end
    s_load_dwordx16 s[64:79], s[0:1], 0
    s_getpc_b64 s[4:5]
L_pc:
    v_lshlrev_b32 v3, 7, v0
    v_mov_b32 v5, s5
    v_add_co_u32 v4, vcc, s4, v3
    v_cmp_gt_u32 s[6:7], 16, v0
    v_and_b32 v1, 63, v0
    v_addc_co_u32 v5, vcc, 0, v5, vcc
    s_and_b64 exec, exec, s[6:7]
    s_cbranch_execz L_nopf
    global_load_dword v169, v[4:5], off
L_nopf:
    s_mov_b64 exec, -1
    s_load_dwordx2 s[58:59], s[0:1], 112
    s_load_dwordx8 s[80:87], s[0:1], 64
    s_load_dwordx2 s[56:57], s[0:1], 96
    v_lshrrev_b32 v2, 6, v0
    s_nop 0
    v_readfirstlane_b32 s3, v2
    s_mov_b32 s40, 0xffff0000
    s_and_b32 s28, s2, 7
    s_lshr_b32 s29, s2, 3
    s_lshl_b32 s32, s28, 5
    s_or_b32 s32, s32, s29
    v_and_b32 v3, 31, v0
    v_lshrrev_b32 v2, 5, v0
    s_lshl_b32 s33, s29, 6
    v_lshl_add_u32 v4, v2, 3, s33
    s_lshl_b32 s33, s28, 7
    v_lshl_add_u32 v5, v3, 2, s33
    v_lshl_add_u32 v5, v4, 10, v5
    v_subrev_u32 v4, 0xc00, v5
    s_lshl_b32 s33, s28, 9
    v_lshl_add_u32 v13, v3, 4, s33
    s_movk_i32 s35, 0x1000
    s_mov_b32 s15, 0x20000
    s_mov_b32 s27, 0x20000
    s_mov_b32 s19, 0x20000
    s_mov_b32 s23, 0x20000
    s_mov_b32 s11, 0x20000
    s_mov_b32 s55, 0x20000
    v_lshlrev_b32 v15, 4, v1
    v_mov_b32 v21, 0
    v_lshlrev_b32 v14, 4, v0
    s_waitcnt lgkmcnt(0)
    s_mov_b32 s12, s70
    s_mov_b32 s13, s71
    s_mov_b32 s14, 0x1000
    s_mov_b32 s24, s68
    s_mov_b32 s25, s69
    s_mov_b32 s26, 0x200000
    buffer_load_dwordx4 v[48:51], v13, s[12:15], 0 offen
    s_mov_b32 s12, s66
    s_mov_b32 s13, s67
    s_mov_b32 s14, 0x200000
    buffer_load_dword v24, v4, s[12:15], 0 offen offset:0
    buffer_load_dword v25, v4, s[12:15], 0 offen offset:1024
    buffer_load_dword v26, v4, s[12:15], 0 offen offset:2048
    buffer_load_dword v27, v5, s[12:15], 0 offen offset:0
    buffer_load_dword v36, v5, s[24:27], 0 offen offset:0
    buffer_load_dword v28, v5, s[12:15], 0 offen offset:1024
    buffer_load_dword v37, v5, s[24:27], 0 offen offset:1024
    buffer_load_dword v29, v5, s[12:15], 0 offen offset:2048
    buffer_load_dword v38, v5, s[24:27], 0 offen offset:2048
    buffer_load_dword v30, v5, s[12:15], 0 offen offset:3072
    buffer_load_dword v39, v5, s[24:27], 0 offen offset:3072
    buffer_load_dword v31, v5, s[12:15], s35 offen offset:0
    buffer_load_dword v40, v5, s[24:27], s35 offen offset:0
    buffer_load_dword v32, v5, s[12:15], s35 offen offset:1024
    buffer_load_dword v41, v5, s[24:27], s35 offen offset:1024
    buffer_load_dword v33, v5, s[12:15], s35 offen offset:2048
    buffer_load_dword v42, v5, s[24:27], s35 offen offset:2048
    buffer_load_dword v34, v5, s[12:15], s35 offen offset:3072
    buffer_load_dword v43, v5, s[24:27], s35 offen offset:3072
    s_add_u32 s4, s58, 0x1408000
    s_addc_u32 s5, s59, 0
    s_load_dword s50, s[4:5], 0
    s_getpc_b64 s[6:7]
L_pc2:
    s_lshl_b32 s36, s29, 2
    s_add_u32 s36, s36, s3
    v_and_b32 v4, 1, v0
    v_lshl_add_u32 v4, s36, 1, v4
    v_min_u32 v4, (L_last-L_pc2)/128, v4
    v_lshlrev_b32 v4, 7, v4
    v_mov_b32 v5, s7
    v_add_co_u32 v4, vcc, s6, v4
    s_nop 1
    v_addc_co_u32 v5, vcc, 0, v5, vcc
    s_mov_b64 exec, 3
    global_load_dword v168, v[4:5], off
    s_mov_b64 exec, -1
    s_lshl_b32 s33, s32, 2
    s_add_u32 s6, s74, s33
    s_addc_u32 s7, s75, 0
    s_load_dword s34, s[6:7], 0
    s_lshl_b32 s33, s32, 13
    s_mul_i32 s30, s28, 6
    s_lshr_b32 s31, s29, 2
    s_add_u32 s30, s30, s31
    s_and_b32 s31, s29, 3
    s_lshl_b32 s46, s30, 2
    s_or_b32 s46, s46, s31
    s_lshl_b32 s47, s31, 2
    s_or_b32 s47, s47, s3
    v_and_b32 v16, 1, v0
    v_lshrrev_b32 v17, 3, v1
    v_and_b32 v6, 7, v1
    v_mul_u32_u24 v242, 0x6000, v17
    v_lshl_add_u32 v242, v6, 4, v242
    v_lshlrev_b32 v243, 3, v17
    s_lshl_b32 s36, s3, 11
    s_add_u32 s33, s33, s36
    s_lshr_b32 s30, s32, 4
    s_and_b32 s31, s32, 15
    s_and_b32 s98, s30, 0
    s_lshl_b32 s98, s98, 2
    s_add_u32 s98, s98, s28
    s_and_b32 s98, s98, 7
    s_lshr_b32 s38, s3, 1
    s_and_b32 s39, s3, 1
    s_cmp_eq_u32 s38, 0
    s_cselect_b32 s20, s78, s80
    s_cselect_b32 s21, s79, s81
    s_mov_b32 s22, 1835008
    s_mov_b32 s8, s82
    s_mov_b32 s9, s83
    s_mov_b32 s10, 0x1c0000
    s_mov_b32 s16, s58
    s_mov_b32 s17, s59
    s_mov_b32 s18, 0x1500000
    s_lshl_b32 s36, s28, 12
    s_add_u32 s36, s36, 0x1410000
    s_add_u32 s52, s58, s36
    s_addc_u32 s53, s59, 0
    s_movk_i32 s54, 0x1000
    s_cmp_eq_u32 s3, 3
    s_cselect_b32 s37, 0, 0x70000000
    v_mov_b32 v22, s37
    s_lshl_b32 s36, s29, 7
    buffer_load_dword v158, v22, s[52:55], s36 offen
    s_lshl_b32 s36, s46, 6
    s_add_u32 s36, s36, 0x1400000
    buffer_load_dword v159, v22, s[16:19], s36 offen
    s_lshl_b32 s36, s32, 13
    s_lshl_b32 s37, s46, 11
    s_add_u32 s37, s37, 0x1480000
    s_cmp_eq_u32 s3, 1
    s_cselect_b32 s37, s37, 0x1500000
    s_cselect_b32 s44, 15, 63
    s_cmp_eq_u32 s3, 2
    s_cselect_b32 s37, s36, s37
    v_and_b32 v4, s44, v1
    v_lshlrev_b32 v4, 7, v4
    buffer_load_dword v157, v4, s[16:19], s37 offen
    v_add_u32 v4, 0, v1
    v_mul_u32_u24 v5, 0x2aab, v4
    v_lshrrev_b32 v5, 16, v5
    v_mul_u32_u24 v5, 3488, v5
    v_lshl_add_u32 v10, v4, 4, v5
    v_add_u32 v4, 64, v1
    v_mul_u32_u24 v5, 0x2aab, v4
    v_lshrrev_b32 v5, 16, v5
    v_mul_u32_u24 v5, 3488, v5
    v_lshl_add_u32 v11, v4, 4, v5
    v_subrev_u32 v11, 1024, v11
    v_add_u32 v4, 128, v1
    v_mul_u32_u24 v5, 0x2aab, v4
    v_lshrrev_b32 v5, 16, v5
    v_mul_u32_u24 v5, 3488, v5
    v_lshl_add_u32 v12, v4, 4, v5
    v_subrev_u32 v12, 2048, v12
    s_mul_i32 s41, s39, 114688
    s_mul_i32 s43, s31, 96
    s_add_u32 s41, s41, s43
    s_add_u32 s41, s41, 0x800
    s_mul_i32 s43, s39, 3072
    s_mul_i32 s42, s38, 49280
    s_add_u32 s42, s42, s43
    s_add_u32 s99, s41, 1835008
    s_mul_i32 s36, s98, 229376
    s_add_u32 s41, s41, s36
    v_lshrrev_b32 v4, 3, v1
    v_bfe_u32 v5, v1, 4, 1
    v_lshlrev_b32 v5, 2, v5
    v_xor_b32 v5, v5, v6
    v_lshlrev_b32 v5, 4, v5
    v_lshl_add_u32 v8, v4, 7, v5
    v_add_u32 v9, 0, v8
    s_lshl_b32 s43, s38, 5
    v_xor_b32 v5, s43, v5
    v_mul_u32_u24 v7, 3584, v4
    v_add_u32 v7, v7, v5
    s_mul_i32 s48, s39, 28672
    s_lshl_b32 s43, s31, 7
    s_add_u32 s48, s48, s43
    s_lshl_b32 s43, s39, 10
    s_mul_i32 s49, s38, 30720
    s_add_u32 s49, s49, s43
    s_mul_i32 s38, s38, 49280
    s_add_u32 s43, s43, s38
    v_sub_u32 v4, 7, v2
    v_xor_b32 v4, v4, v6
    v_lshl_add_u32 v4, v3, 4, v4
    v_lshlrev_b32 v4, 4, v4
    v_add_u32 v120, 124416, v4
    v_lshrrev_b32 v4, 4, v1
    v_xor_b32 v5, v4, v1
    s_lshl_b32 s36, s3, 11
    s_add_u32 s36, s36, 124416
    v_lshl_add_u32 v124, v5, 4, s36
    v_xor_b32 v125, 64, v124
    v_lshrrev_b32 v4, 3, v1
    v_lshlrev_b32 v5, 4, v6
    v_lshl_add_u32 v13, v4, 12, v5
    s_lshl_b32 s36, s28, 2
    s_add_u32 s36, s36, s3
    s_lshl_b32 s36, s36, 16
    s_sub_u32 s35, 31, s29
    s_lshl_b32 s35, s35, 7
    s_add_u32 s35, s35, s36
    s_waitcnt vmcnt(23)
    v_lshlrev_b32 v52, 16, v48
    v_and_b32 v54, s40, v48
    v_lshlrev_b32 v56, 16, v49
    v_and_b32 v58, s40, v49
    v_lshlrev_b32 v53, 16, v50
    v_and_b32 v55, s40, v50
    v_lshlrev_b32 v57, 16, v51
    v_and_b32 v59, s40, v51
    s_waitcnt vmcnt(18)
    s_mov_b32 s12, s72
    s_mov_b32 s13, s73
    s_mov_b32 s14, 0x200000
    s_lshl_b32 s36, s32, 13
    buffer_load_dwordx4 v[146:149], v14, s[12:15], s36 offen
    s_add_u32 s36, s36, 0x1000
    buffer_load_dwordx4 v[150:153], v14, s[12:15], s36 offen
    v_lshlrev_b32 v60, 16, v24
    v_and_b32 v61, s40, v24
    v_lshlrev_b32 v62, 16, v25
    v_and_b32 v63, s40, v25
    v_lshlrev_b32 v64, 16, v26
    v_and_b32 v65, s40, v26
    v_lshlrev_b32 v66, 16, v27
    v_and_b32 v67, s40, v27
    v_lshlrev_b32 v84, 16, v36
    v_and_b32 v85, s40, v36
    v_pk_mul_f32 v[102:103], v[60:61], v[58:59]
    v_pk_fma_f32 v[102:103], v[62:63], v[56:57], v[102:103]
    v_pk_fma_f32 v[102:103], v[64:65], v[54:55], v[102:103]
    v_pk_fma_f32 v[102:103], v[66:67], v[52:53], v[102:103]
    v_pk_mul_f32 v[102:103], v[102:103], v[84:85]
    s_waitcnt vmcnt(18)
    v_lshlrev_b32 v68, 16, v28
    v_and_b32 v69, s40, v28
    v_lshlrev_b32 v86, 16, v37
    v_and_b32 v87, s40, v37
    v_pk_mul_f32 v[104:105], v[62:63], v[58:59]
    v_pk_fma_f32 v[104:105], v[64:65], v[56:57], v[104:105]
    v_pk_fma_f32 v[104:105], v[66:67], v[54:55], v[104:105]
    v_pk_fma_f32 v[104:105], v[68:69], v[52:53], v[104:105]
    v_pk_mul_f32 v[104:105], v[104:105], v[86:87]
    s_waitcnt vmcnt(16)
    v_lshlrev_b32 v70, 16, v29
    v_and_b32 v71, s40, v29
    v_lshlrev_b32 v88, 16, v38
    v_and_b32 v89, s40, v38
    v_pk_mul_f32 v[106:107], v[64:65], v[58:59]
    v_pk_fma_f32 v[106:107], v[66:67], v[56:57], v[106:107]
    v_pk_fma_f32 v[106:107], v[68:69], v[54:55], v[106:107]
    v_pk_fma_f32 v[106:107], v[70:71], v[52:53], v[106:107]
    v_pk_mul_f32 v[106:107], v[106:107], v[88:89]
    s_waitcnt vmcnt(14)
    v_lshlrev_b32 v72, 16, v30
    v_and_b32 v73, s40, v30
    v_lshlrev_b32 v90, 16, v39
    v_and_b32 v91, s40, v39
    v_pk_mul_f32 v[108:109], v[66:67], v[58:59]
    v_pk_fma_f32 v[108:109], v[68:69], v[56:57], v[108:109]
    v_pk_fma_f32 v[108:109], v[70:71], v[54:55], v[108:109]
    v_pk_fma_f32 v[108:109], v[72:73], v[52:53], v[108:109]
    v_pk_mul_f32 v[108:109], v[108:109], v[90:91]
    s_waitcnt vmcnt(12)
    v_lshlrev_b32 v74, 16, v31
    v_and_b32 v75, s40, v31
    v_lshlrev_b32 v92, 16, v40
    v_and_b32 v93, s40, v40
    v_pk_mul_f32 v[110:111], v[68:69], v[58:59]
    v_pk_fma_f32 v[110:111], v[70:71], v[56:57], v[110:111]
    v_pk_fma_f32 v[110:111], v[72:73], v[54:55], v[110:111]
    v_pk_fma_f32 v[110:111], v[74:75], v[52:53], v[110:111]
    v_pk_mul_f32 v[110:111], v[110:111], v[92:93]
    s_waitcnt vmcnt(10)
    v_lshlrev_b32 v76, 16, v32
    v_and_b32 v77, s40, v32
    v_lshlrev_b32 v94, 16, v41
    v_and_b32 v95, s40, v41
    v_pk_mul_f32 v[112:113], v[70:71], v[58:59]
    v_pk_fma_f32 v[112:113], v[72:73], v[56:57], v[112:113]
    v_pk_fma_f32 v[112:113], v[74:75], v[54:55], v[112:113]
    v_pk_fma_f32 v[112:113], v[76:77], v[52:53], v[112:113]
    v_pk_mul_f32 v[112:113], v[112:113], v[94:95]
    s_waitcnt vmcnt(8)
    v_lshlrev_b32 v78, 16, v33
    v_and_b32 v79, s40, v33
    v_lshlrev_b32 v96, 16, v42
    v_and_b32 v97, s40, v42
    v_pk_mul_f32 v[114:115], v[72:73], v[58:59]
    v_pk_fma_f32 v[114:115], v[74:75], v[56:57], v[114:115]
    v_pk_fma_f32 v[114:115], v[76:77], v[54:55], v[114:115]
    v_pk_fma_f32 v[114:115], v[78:79], v[52:53], v[114:115]
    v_pk_mul_f32 v[114:115], v[114:115], v[96:97]
    s_waitcnt vmcnt(6)
    v_lshlrev_b32 v80, 16, v34
    v_and_b32 v81, s40, v34
    v_lshlrev_b32 v98, 16, v43
    v_and_b32 v99, s40, v43
    v_pk_mul_f32 v[116:117], v[74:75], v[58:59]
    v_pk_fma_f32 v[116:117], v[76:77], v[56:57], v[116:117]
    v_pk_fma_f32 v[116:117], v[78:79], v[54:55], v[116:117]
    v_pk_fma_f32 v[116:117], v[80:81], v[52:53], v[116:117]
    v_pk_mul_f32 v[116:117], v[116:117], v[98:99]
    s_mov_b64 s[96:97], s[64:65]
    v_cvt_pk_bf16_f32 v24, v116, v114
    v_cvt_pk_bf16_f32 v25, v112, v110
    v_cvt_pk_bf16_f32 v26, v108, v106
    v_cvt_pk_bf16_f32 v27, v104, v102
    ds_write_b128 v120, v[24:27] offset:0
    v_cvt_pk_bf16_f32 v28, v117, v115
    v_cvt_pk_bf16_f32 v29, v113, v111
    v_cvt_pk_bf16_f32 v30, v109, v107
    v_cvt_pk_bf16_f32 v31, v105, v103
    ds_write_b128 v120, v[28:31] offset:128
    s_waitcnt lgkmcnt(0)
    s_barrier
    ds_read_b128 v[104:107], v124 offset:0
    ds_read_b128 v[108:111], v125 offset:1024
    s_mul_i32 s50, s50, 1664525
    s_add_u32 s50, s50, 1013904223
    v_mov_b32 v20, s50
    s_getreg_b32 s100, hwreg(HW_REG_XCC_ID, 0, 4)
    s_add_u32 s100, s100, s50
    s_add_u32 s100, s100, 1
    s_mov_b32 s24, s35
    s_add_u32 s25, s35, 0x8000
    s_waitcnt lgkmcnt(1)
    buffer_store_dwordx4 v[104:107], v13, s[16:19], s24 offen
    s_waitcnt lgkmcnt(0)
    buffer_store_dwordx4 v[108:111], v13, s[16:19], s25 offen
    s_lshl_b32 s7, s3, 7
    s_lshl_b32 s36, s29, 2
    s_add_u32 s7, s7, s36
    v_mov_b32 v123, s100
    s_mov_b32 s12, s84
    s_mov_b32 s13, s85
    s_mov_b32 s14, 0x400
    s_lshl_b32 s36, s47, 6
    buffer_load_dwordx2 v[144:145], v243, s[12:15], s36 offen
    s_mov_b32 s12, s86
    s_mov_b32 s13, s87
    s_mov_b32 s14, 0x300000
    s_cmp_lt_u32 s29, 24
    s_cselect_b32 s14, s14, 0
    s_lshr_b32 s36, s46, 2
    s_lshl_b32 s36, s36, 7
    s_mul_i32 s37, s47, 196608
    s_add_u32 s36, s36, s37
    buffer_load_dwordx4 v[128:131], v242, s[12:15], s36 offen
    s_add_u32 s36, s36, 0x1800
    buffer_load_dwordx4 v[132:135], v242, s[12:15], s36 offen
    s_add_u32 s36, s36, 0x1800
    buffer_load_dwordx4 v[136:139], v242, s[12:15], s36 offen
    s_add_u32 s36, s36, 0x1800
    buffer_load_dwordx4 v[140:143], v242, s[12:15], s36 offen
    v_mov_b32 v40, 0
    v_mov_b32 v41, 0
    v_mov_b32 v42, 0
    v_mov_b32 v43, 0
    v_add_u32 v14, 98432, v14
    v_cmp_gt_u32 vcc, 32, v0
    s_nop 0
    s_and_saveexec_b64 s[36:37], vcc
    s_cbranch_execz L_nz
    ds_write_b128 v14, v[40:43]
    ds_write_b128 v14, v[40:43] offset:12992
    v_cmp_gt_u32 vcc, 2, v0
    s_nop 0
    s_and_b64 exec, exec, vcc
    ds_write_b128 v14, v[40:43] offset:8704
    ds_write_b128 v14, v[40:43] offset:12864
    ds_write_b128 v14, v[40:43] offset:21696
    ds_write_b128 v14, v[40:43] offset:25856
L_nz:
    s_mov_b64 exec, s[36:37]
    v_cmp_eq_u32 s[36:37], 0, v0
    s_lshl_b32 s4, s34, 16
    s_and_b32 s5, s34, 0xffff0000
    s_mov_b32 s6, 0xffff
    s_waitcnt vmcnt(7)
    v_lshlrev_b32 v44, 16, v146
    v_add_f32 v44, s4, v44
    v_cvt_pk_bf16_f32 v44, v44, v44
    v_bfi_b32 v44, s6, v44, v146
    v_cndmask_b32 v146, v146, v44, s[36:37]
    ds_write_b128 v14, v[146:149] offset:512
    v_lshlrev_b32 v44, 16, v150
    v_add_f32 v44, s5, v44
    v_cvt_pk_bf16_f32 v44, v44, v44
    v_bfi_b32 v44, s6, v44, v150
    v_cndmask_b32 v150, v150, v44, s[36:37]
    ds_write_b128 v14, v[150:153] offset:13504
    s_waitcnt vmcnt(5)
    s_mov_b64 exec, 0x1
    buffer_store_dword v123, v21, s[52:55], s7 offen offset:128
    s_mov_b64 exec, -1
    v_and_b32 v120, 31, v1
    v_lshlrev_b32 v120, 2, v120
    s_lshr_b32 s5, s29, 3
    s_lshl_b32 s5, s5, 7
    v_mov_b32 v121, s50
    s_mov_b64 exec, 0xffffffff
    buffer_load_dword v124, v120, s[52:55], s5 offen offset:128 sc1
    s_mov_b64 exec, -1
    s_mov_b32 s12, s96
    s_mov_b32 s13, s97
    s_mov_b32 s14, 0x200000
    v_lshrrev_b32 v4, 1, v6
    v_lshlrev_b32 v4, 11, v4
    v_lshl_add_u32 v4, v16, 6, v4
    v_lshrrev_b32 v5, 5, v1
    v_lshl_add_u32 v4, v5, 5, v4
    v_bfe_u32 v5, v1, 4, 1
    v_lshl_add_u32 v126, v5, 4, v4
    s_lshl_b32 s35, s32, 13
    s_add_u32 s34, s35, 0x1000
    v_lshlrev_b32 v125, 4, v0
    s_waitcnt vmcnt(6)
    v_lshlrev_b32 v44, 16, v144
    v_and_b32 v45, s40, v144
    v_lshlrev_b32 v46, 16, v145
    v_and_b32 v47, s40, v145
    v_mul_f32 v48, 0xbfb8aa3b, v44
    v_mul_f32 v49, 0xbfb8aa3b, v45
    v_mul_f32 v50, 0xbfb8aa3b, v46
    v_mul_f32 v51, 0xbfb8aa3b, v47
    v_exp_f32 v48, v48
    v_exp_f32 v49, v49
    v_exp_f32 v50, v50
    v_exp_f32 v51, v51
    v_add_f32 v48, 1.0, v48
    v_add_f32 v49, 1.0, v49
    v_add_f32 v50, 1.0, v50
    v_add_f32 v51, 1.0, v51
    v_rcp_f32 v48, v48
    v_rcp_f32 v49, v49
    v_rcp_f32 v50, v50
    v_rcp_f32 v51, v51
    v_mul_f32 v44, v44, v48
    v_mul_f32 v45, v45, v49
    v_mul_f32 v46, v46, v50
    v_mul_f32 v47, v47, v51
    v_cvt_pk_bf16_f32 v48, v44, v45
    v_cvt_pk_bf16_f32 v49, v46, v47
    v_lshlrev_b32 v44, 16, v48
    v_and_b32 v45, s40, v48
    v_lshlrev_b32 v46, 16, v49
    v_and_b32 v47, s40, v49
    s_lshr_b32 s36, s3, 1
    s_mul_i32 s36, s36, 12992
    s_xor_b32 s38, s39, 1
    s_lshl_b32 s38, s38, 6
    s_add_u32 s36, s36, s38
    s_add_u32 s36, s36, 98432
    v_and_b32 v3, 15, v0
    v_bfe_u32 v4, v0, 4, 2
    v_lshlrev_b32 v5, 4, v4
    v_lshl_add_u32 v22, v3, 5, v5
    s_add_u32 s38, s36, 32
    v_add_u32 v22, s38, v22
    v_and_b32 v23, 14, v3
    v_lshlrev_b32 v23, 1, v23
    v_sub_u32 v23, v5, v23
    v_mul_u32_u24 v5, 4160, v16
    v_sub_u32 v23, v23, v5
    s_add_u32 s38, s36, 8796
    v_add_u32 v16, s38, v23
    v_add_u32 v17, 1024, v16
    v_add_u32 v18, 2048, v16
    v_add_u32 v19, 3072, v16
    v_bfe_u32 v5, v3, 1, 2
    v_xor_b32 v5, v5, v4
    v_lshl_add_u32 v5, v3, 2, v5
    s_lshl_b32 s38, s3, 13
    s_add_u32 s38, s38, 124416
    v_lshl_add_u32 v23, v5, 4, s38
    s_waitcnt lgkmcnt(0)
    s_barrier
    ds_read_b128 v[156:159], v22 offset:1664
    ds_read_b128 v[160:163], v22 offset:1792
    ds_read_b128 v[164:167], v22 offset:1920
    ds_read_b128 v[168:171], v22 offset:2048
    ds_read_b128 v[172:175], v22 offset:2176
    ds_read_b128 v[176:179], v22 offset:2304
    ds_read_b128 v[180:183], v22 offset:2432
    ds_read_b128 v[184:187], v22 offset:2560
    ds_read_b128 v[188:191], v22 offset:2688
    ds_read_b128 v[192:195], v22 offset:2816
    ds_read_b128 v[196:199], v22 offset:2944
    ds_read_b128 v[200:203], v22 offset:3072
    ds_read_b128 v[204:207], v22 offset:3200
    ds_read_b128 v[208:211], v22 offset:3328
    ds_read_b128 v[212:215], v22 offset:3456
    ds_read_b128 v[216:219], v22 offset:3584
    ds_read_b128 v[220:223], v22 offset:3712
    ds_read_b128 v[224:227], v22 offset:3840
    ds_read_b128 v[228:231], v22 offset:3968
    s_mov_b32 s51, 32768
    s_mov_b32 s101, 0
    s_waitcnt vmcnt(0)
    s_mov_b32 exec_hi, 0
    s_branch L_uh_chk
L_uh:
    s_sleep 1
    s_cmp_lg_u32 s51, 32720
    s_cbranch_scc1 L_noid
    s_cmp_lg_u32 s3, 0
    s_cbranch_scc1 L_noid
    s_lshl_b32 s36, s29, 2
    s_mov_b64 exec, 1
    buffer_store_dword v123, v21, s[52:55], s36 offen offset:0 sc1
    s_mov_b64 exec, 0xffffffff
L_noid:
    buffer_load_dword v121, v120, s[52:55], 0 offen offset:0 sc1
    buffer_load_dword v124, v120, s[52:55], s5 offen offset:128 sc1
    s_waitcnt vmcnt(0)
L_uh_chk:
    v_cmp_ne_u32 vcc, s100, v124
    v_subrev_u32 v122, s50, v121
    v_subrev_u32 v122, 1, v122
    s_cbranch_vccz L_uh_ok
    v_cmp_lt_u32 vcc, 15, v122
    v_cmp_ne_u32 s[92:93], s100, v121
    s_sub_u32 s51, s51, 1
    s_cbranch_scc1 L_uh_ok
    s_cbranch_vccnz L_uh
    s_cmp_eq_u64 s[92:93], 0
    s_cbranch_scc1 L_uh_same
    s_cmp_lg_u32 s101, 0
    s_cbranch_scc1 L_uh_same
    s_mov_b32 s101, 1
    s_mov_b64 exec, -1
    buffer_store_dwordx4 v[104:107], v13, s[16:19], s24 offen sc1
    buffer_store_dwordx4 v[108:111], v13, s[16:19], s25 offen sc1
    s_waitcnt vmcnt(0)
    buffer_store_dword v20, v21, s[52:55], s7 offen offset:128 sc1
    s_mov_b32 exec_hi, 0
L_uh_same:
    v_cmp_ne_u32 vcc, s50, v124
    v_cmp_ne_u32 s[92:93], s100, v124
    s_nop 0
    s_and_b64 vcc, vcc, s[92:93]
    s_cbranch_vccnz L_uh
L_uh_ok:
    s_mov_b64 exec, -1
    buffer_load_dwordx4 v[72:75], v125, s[16:19], s35 offen sc1
    buffer_load_dword v80, v125, s[16:19], s35 offen offset:16 sc1
    buffer_load_dwordx4 v[76:79], v125, s[16:19], s34 offen sc1
    buffer_load_dword v81, v125, s[16:19], s34 offen offset:16 sc1
    v_lshlrev_b32 v52, 16, v128
    v_and_b32 v53, s40, v128
    v_lshlrev_b32 v54, 16, v129
    v_and_b32 v55, s40, v129
    v_lshlrev_b32 v56, 16, v130
    v_and_b32 v57, s40, v130
    v_lshlrev_b32 v58, 16, v131
    v_and_b32 v59, s40, v131
    v_pk_mul_f32 v[60:61], v[52:53], v[44:45] op_sel:[0,0] op_sel_hi:[1,0]
    v_pk_mul_f32 v[62:63], v[54:55], v[44:45] op_sel:[0,0] op_sel_hi:[1,0]
    v_pk_mul_f32 v[64:65], v[56:57], v[44:45] op_sel:[0,0] op_sel_hi:[1,0]
    v_pk_mul_f32 v[66:67], v[58:59], v[44:45] op_sel:[0,0] op_sel_hi:[1,0]
    v_lshlrev_b32 v52, 16, v132
    v_and_b32 v53, s40, v132
    v_lshlrev_b32 v54, 16, v133
    v_and_b32 v55, s40, v133
    v_lshlrev_b32 v56, 16, v134
    v_and_b32 v57, s40, v134
    v_lshlrev_b32 v58, 16, v135
    v_and_b32 v59, s40, v135
    v_pk_fma_f32 v[60:61], v[52:53], v[44:45], v[60:61] op_sel:[0,1,0] op_sel_hi:[1,1,1]
    v_pk_fma_f32 v[62:63], v[54:55], v[44:45], v[62:63] op_sel:[0,1,0] op_sel_hi:[1,1,1]
    v_pk_fma_f32 v[64:65], v[56:57], v[44:45], v[64:65] op_sel:[0,1,0] op_sel_hi:[1,1,1]
    v_pk_fma_f32 v[66:67], v[58:59], v[44:45], v[66:67] op_sel:[0,1,0] op_sel_hi:[1,1,1]
    v_lshlrev_b32 v52, 16, v136
    v_and_b32 v53, s40, v136
    v_lshlrev_b32 v54, 16, v137
    v_and_b32 v55, s40, v137
    v_lshlrev_b32 v56, 16, v138
    v_and_b32 v57, s40, v138
    v_lshlrev_b32 v58, 16, v139
    v_and_b32 v59, s40, v139
    v_pk_fma_f32 v[60:61], v[52:53], v[46:47], v[60:61] op_sel:[0,0,0] op_sel_hi:[1,0,1]
    v_pk_fma_f32 v[62:63], v[54:55], v[46:47], v[62:63] op_sel:[0,0,0] op_sel_hi:[1,0,1]
    v_pk_fma_f32 v[64:65], v[56:57], v[46:47], v[64:65] op_sel:[0,0,0] op_sel_hi:[1,0,1]
    v_pk_fma_f32 v[66:67], v[58:59], v[46:47], v[66:67] op_sel:[0,0,0] op_sel_hi:[1,0,1]
    v_lshlrev_b32 v52, 16, v140
    v_and_b32 v53, s40, v140
    v_lshlrev_b32 v54, 16, v141
    v_and_b32 v55, s40, v141
    v_lshlrev_b32 v56, 16, v142
    v_and_b32 v57, s40, v142
    v_lshlrev_b32 v58, 16, v143
    v_and_b32 v59, s40, v143
    v_pk_fma_f32 v[60:61], v[52:53], v[46:47], v[60:61] op_sel:[0,1,0] op_sel_hi:[1,1,1]
    v_pk_fma_f32 v[62:63], v[54:55], v[46:47], v[62:63] op_sel:[0,1,0] op_sel_hi:[1,1,1]
    v_pk_fma_f32 v[64:65], v[56:57], v[46:47], v[64:65] op_sel:[0,1,0] op_sel_hi:[1,1,1]
    v_pk_fma_f32 v[66:67], v[58:59], v[46:47], v[66:67] op_sel:[0,1,0] op_sel_hi:[1,1,1]
    s_nop 0
    v_permlane32_swap_b32 v60, v64
    v_permlane32_swap_b32 v61, v65
    v_permlane32_swap_b32 v62, v66
    v_permlane32_swap_b32 v63, v67
    v_add_f32 v60, v60, v64
    v_add_f32 v61, v61, v65
    v_add_f32 v62, v62, v66
    v_add_f32 v63, v63, v67
    s_lshr_b32 s6, s46, 2
    s_lshl_b32 s6, s6, 13
    v_permlane16_swap_b32 v60, v62
    v_permlane16_swap_b32 v61, v63
    s_lshl_b32 s36, s47, 7
    v_add_f32 v100, v60, v62
    v_add_f32 v101, v61, v63
    v_mov_b32 v102, s50
    v_mov_b32 v103, s50
    v_add_f32_dpp v100, v100, v100 row_ror:8 row_mask:0xf bank_mask:0xf
    v_add_f32_dpp v101, v101, v101 row_ror:8 row_mask:0xf bank_mask:0xf
    s_add_u32 s6, s6, s36
    s_add_u32 s6, s6, 0x1480000
    s_cmp_lt_u32 s29, 24
    s_cselect_b32 s6, s6, 0x1500000
    s_cmp_eq_u32 s101, 0
    s_cbranch_scc1 L_ls0a
    buffer_store_dwordx4 v[100:103], v126, s[16:19], s6 offen sc1
    s_branch L_ls0b
L_ls0a:
    buffer_store_dwordx4 v[100:103], v126, s[16:19], s6 offen
L_ls0b:
    ds_read_b128 v[104:107], v22 offset:0
    ds_read_b128 v[108:111], v22 offset:128
    ds_read_b128 v[112:115], v22 offset:256
    ds_read_b128 v[116:119], v22 offset:384
    ds_read_b128 v[120:123], v22 offset:512
    ds_read_b128 v[124:127], v22 offset:640
    ds_read_b128 v[128:131], v22 offset:768
    ds_read_b128 v[132:135], v22 offset:896
    ds_read_b128 v[136:139], v22 offset:1024
    ds_read_b128 v[140:143], v22 offset:1152
    ds_read_b128 v[144:147], v22 offset:1280
    ds_read_b128 v[148:151], v22 offset:1408
    ds_read_b128 v[152:155], v22 offset:1536
    buffer_load_dwordx4 v[232:235], v15, s[12:15], s33 offen
    buffer_load_dwordx4 v[236:239], v15, s[12:15], s33 offen offset:1024
    s_mul_i32 s44, s2, 7
    s_lshl_b32 s45, s3, 1
    s_add_u32 s44, s44, s45
    s_cmp_eq_u32 s3, 3
    s_cselect_b32 s45, 0, 1
    s_add_u32 s45, s45, s44
    s_lshl_b32 s36, s44, 10
    buffer_load_dwordx4 v[32:35], v15, s[8:11], s36 offen
    s_lshl_b32 s36, s45, 10
    buffer_load_dwordx4 v[36:39], v15, s[8:11], s36 offen
    s_movk_i32 s36, 0xff
    v_cmp_ne_u32 vcc, s36, v0
    s_waitcnt vmcnt(7)
    s_nop 0
    v_cndmask_b32 v80, 0, v80, vcc
    ds_write_b128 v14, v[72:75] offset:4608
    v_alignbit_b32 v40, v73, v72, 16
    v_alignbit_b32 v41, v74, v73, 16
    v_alignbit_b32 v42, v75, v74, 16
    v_alignbit_b32 v43, v80, v75, 16
    ds_write_b128 v14, v[40:43] offset:8768
    s_waitcnt vmcnt(5)
    v_cndmask_b32 v81, 0, v81, vcc
    ds_write_b128 v14, v[76:79] offset:17600
    v_alignbit_b32 v44, v77, v76, 16
    v_alignbit_b32 v45, v78, v77, 16
    v_alignbit_b32 v46, v79, v78, 16
    v_alignbit_b32 v47, v81, v79, 16
    ds_write_b128 v14, v[44:47] offset:21760
    s_add_u32 m0, s42, 0
    s_nop 0
    buffer_load_dwordx4 v10, s[20:23], s41 offen offset:0 lds
    buffer_load_dwordx4 v11, s[20:23], s41 offen offset:1024 lds
    buffer_load_dwordx4 v12, s[20:23], s41 offen offset:2048 lds
    s_add_u32 s41, s41, 229376
    s_cmp_eq_u32 s41, s99
    s_cselect_b32 s36, 1835008, 0
    s_sub_u32 s41, s41, s36
    s_waitcnt lgkmcnt(0)
    s_barrier
    s_lshl_b32 s6, s46, 11
    s_add_u32 s6, s6, 0x1480000
    s_lshl_b32 s5, s46, 6
    s_add_u32 s5, s5, 0x1400000
    s_cmp_lt_u32 s29, 24
    s_cselect_b32 s7, s3, 1
    s_cmp_eq_u32 s7, 0
    s_cselect_b32 s6, s6, 0x1500000
    s_cselect_b32 s5, s5, 0x1500000
    s_lshr_b32 s36, s46, 5
    s_cmp_eq_u32 s36, 1
    s_cselect_b32 s4, 1.0, 0
    s_cmp_eq_u32 s36, 4
    s_cselect_b32 s4, 1.0, s4
    ds_read2_b32 v[72:73], v19 offset0:224 offset1:225
    ds_read2_b32 v[74:75], v19 offset0:226 offset1:227
    ds_read2_b32 v[76:77], v19 offset0:192 offset1:193
    ds_read2_b32 v[78:79], v19 offset0:194 offset1:195
    ds_read2_b32 v[80:81], v19 offset0:160 offset1:161
    ds_read2_b32 v[82:83], v19 offset0:162 offset1:163
    ds_read2_b32 v[84:85], v19 offset0:128 offset1:129
    ds_read2_b32 v[86:87], v19 offset0:130 offset1:131
    ds_read2_b32 v[88:89], v19 offset0:96 offset1:97
    ds_read2_b32 v[90:91], v19 offset0:98 offset1:99
    ds_read2_b32 v[92:93], v19 offset0:64 offset1:65
    ds_read2_b32 v[94:95], v19 offset0:66 offset1:67
    v_lshrrev_b32 v2, 1, v0
    v_bfe_u32 v3, v0, 4, 2
    v_xor_b32 v2, v2, v3
    v_lshlrev_b32 v2, 4, v2
    v_and_b32 v3, 1, v0
    v_lshl_add_u32 v2, v3, 3, v2
    v_add_u32 v2, 124416, v2
    v_lshlrev_b32 v3, 4, v0
    s_mul_i32 s38, s32, 16512
    s_add_u32 s38, s38, 0x400000
    s_waitcnt lgkmcnt(10)
    v_mfma_f32_16x16x32_bf16 v[40:43], v[72:75], v[116:119], 0
    ds_read2_b32 v[96:97], v19 offset0:32 offset1:33
    ds_read2_b32 v[98:99], v19 offset0:34 offset1:35
    v_mfma_f32_16x16x32_bf16 v[44:47], v[72:75], v[132:135], 0
    ds_read2_b32 v[100:101], v19 offset0:0 offset1:1
    v_mfma_f32_16x16x32_bf16 v[48:51], v[72:75], v[148:151], 0
    v_mfma_f32_16x16x32_bf16 v[52:55], v[72:75], v[164:167], 0
    v_mfma_f32_16x16x32_bf16 v[56:59], v[72:75], v[180:183], 0
    v_mfma_f32_16x16x32_bf16 v[60:63], v[72:75], v[196:199], 0
    v_mfma_f32_16x16x32_bf16 v[64:67], v[72:75], v[212:215], 0
    v_mfma_f32_16x16x32_bf16 v[68:71], v[72:75], v[228:231], 0
    s_waitcnt lgkmcnt(11)
    v_mfma_f32_16x16x32_bf16 v[40:43], v[76:79], v[112:115], v[40:43]
    ds_read2_b32 v[102:103], v19 offset0:2 offset1:3
    ds_read2_b32 v[72:73], v18 offset0:224 offset1:225
    v_mfma_f32_16x16x32_bf16 v[44:47], v[76:79], v[128:131], v[44:47]
    v_mfma_f32_16x16x32_bf16 v[48:51], v[76:79], v[144:147], v[48:51]
    v_mfma_f32_16x16x32_bf16 v[52:55], v[76:79], v[160:163], v[52:55]
    v_mfma_f32_16x16x32_bf16 v[56:59], v[76:79], v[176:179], v[56:59]
    v_mfma_f32_16x16x32_bf16 v[60:63], v[76:79], v[192:195], v[60:63]
    v_mfma_f32_16x16x32_bf16 v[64:67], v[76:79], v[208:211], v[64:67]
    v_mfma_f32_16x16x32_bf16 v[68:71], v[76:79], v[224:227], v[68:71]
    s_waitcnt lgkmcnt(11)
    v_mfma_f32_16x16x32_bf16 v[40:43], v[80:83], v[108:111], v[40:43]
    ds_read2_b32 v[74:75], v18 offset0:226 offset1:227
    ds_read2_b32 v[76:77], v18 offset0:192 offset1:193
    v_mfma_f32_16x16x32_bf16 v[44:47], v[80:83], v[124:127], v[44:47]
    s_add_u32 m0, s42, 6144
    s_nop 0
    buffer_load_dwordx4 v10, s[20:23], s41 offen offset:0 lds
    v_mfma_f32_16x16x32_bf16 v[48:51], v[80:83], v[140:143], v[48:51]
    v_mfma_f32_16x16x32_bf16 v[52:55], v[80:83], v[156:159], v[52:55]
    v_mfma_f32_16x16x32_bf16 v[56:59], v[80:83], v[172:175], v[56:59]
    v_mfma_f32_16x16x32_bf16 v[60:63], v[80:83], v[188:191], v[60:63]
    v_mfma_f32_16x16x32_bf16 v[64:67], v[80:83], v[204:207], v[64:67]
    v_mfma_f32_16x16x32_bf16 v[68:71], v[80:83], v[220:223], v[68:71]
    s_waitcnt lgkmcnt(11)
    v_mfma_f32_16x16x32_bf16 v[40:43], v[84:87], v[104:107], v[40:43]
    ds_read2_b32 v[78:79], v18 offset0:194 offset1:195
    ds_read2_b32 v[80:81], v18 offset0:160 offset1:161
    v_mfma_f32_16x16x32_bf16 v[44:47], v[84:87], v[120:123], v[44:47]
    v_mfma_f32_16x16x32_bf16 v[48:51], v[84:87], v[136:139], v[48:51]
    buffer_load_dwordx4 v11, s[20:23], s41 offen offset:1024 lds
    v_mfma_f32_16x16x32_bf16 v[52:55], v[84:87], v[152:155], v[52:55]
    v_mfma_f32_16x16x32_bf16 v[56:59], v[84:87], v[168:171], v[56:59]
    v_mfma_f32_16x16x32_bf16 v[60:63], v[84:87], v[184:187], v[60:63]
    v_mfma_f32_16x16x32_bf16 v[64:67], v[84:87], v[200:203], v[64:67]
    v_mfma_f32_16x16x32_bf16 v[68:71], v[84:87], v[216:219], v[68:71]
    buffer_load_dwordx4 v[240:243], v15, s[16:19], s6 offen offset:0 sc1
    buffer_load_dwordx4 v[244:247], v15, s[16:19], s6 offen offset:1024 sc1
    s_waitcnt lgkmcnt(11)
    v_mfma_f32_16x16x32_bf16 v[44:47], v[88:91], v[116:119], v[44:47]
    ds_read2_b32 v[82:83], v18 offset0:162 offset1:163
    v_mfma_f32_16x16x32_bf16 v[48:51], v[88:91], v[132:135], v[48:51]
    ds_read2_b32 v[84:85], v18 offset0:128 offset1:129
    v_mfma_f32_16x16x32_bf16 v[52:55], v[88:91], v[148:151], v[52:55]
    v_mfma_f32_16x16x32_bf16 v[56:59], v[88:91], v[164:167], v[56:59]
    buffer_load_dwordx4 v12, s[20:23], s41 offen offset:2048 lds
    s_add_u32 s41, s41, 229376
    s_cmp_eq_u32 s41, s99
    s_cselect_b32 s36, 1835008, 0
    s_sub_u32 s41, s41, s36
    v_mfma_f32_16x16x32_bf16 v[60:63], v[88:91], v[180:183], v[60:63]
    v_mfma_f32_16x16x32_bf16 v[64:67], v[88:91], v[196:199], v[64:67]
    v_mfma_f32_16x16x32_bf16 v[68:71], v[88:91], v[212:215], v[68:71]
    ds_write_b128 v23, v[40:43] offset:0
    s_waitcnt lgkmcnt(12)
    v_mfma_f32_16x16x32_bf16 v[44:47], v[92:95], v[112:115], v[44:47]
    ds_read2_b32 v[86:87], v18 offset0:130 offset1:131
    v_mfma_f32_16x16x32_bf16 v[48:51], v[92:95], v[128:131], v[48:51]
    v_mfma_f32_16x16x32_bf16 v[52:55], v[92:95], v[144:147], v[52:55]
    v_mfma_f32_16x16x32_bf16 v[56:59], v[92:95], v[160:163], v[56:59]
    v_mfma_f32_16x16x32_bf16 v[60:63], v[92:95], v[176:179], v[60:63]
    v_mfma_f32_16x16x32_bf16 v[64:67], v[92:95], v[192:195], v[64:67]
    s_add_u32 m0, s42, 12288
    s_nop 0
    buffer_load_dwordx4 v10, s[20:23], s41 offen offset:0 lds
    v_mfma_f32_16x16x32_bf16 v[68:71], v[92:95], v[208:211], v[68:71]
    s_waitcnt lgkmcnt(11)
    v_mfma_f32_16x16x32_bf16 v[44:47], v[96:99], v[108:111], v[44:47]
    ds_read2_b32 v[88:89], v18 offset0:96 offset1:97
    v_mfma_f32_16x16x32_bf16 v[48:51], v[96:99], v[124:127], v[48:51]
    ds_read2_b32 v[90:91], v18 offset0:98 offset1:99
    v_mfma_f32_16x16x32_bf16 v[52:55], v[96:99], v[140:143], v[52:55]
    v_mfma_f32_16x16x32_bf16 v[56:59], v[96:99], v[156:159], v[56:59]
    v_mfma_f32_16x16x32_bf16 v[60:63], v[96:99], v[172:175], v[60:63]
    v_mfma_f32_16x16x32_bf16 v[64:67], v[96:99], v[188:191], v[64:67]
    v_mfma_f32_16x16x32_bf16 v[68:71], v[96:99], v[204:207], v[68:71]
    s_waitcnt lgkmcnt(11)
    v_mfma_f32_16x16x32_bf16 v[44:47], v[100:103], v[104:107], v[44:47]
    ds_read2_b32 v[92:93], v18 offset0:64 offset1:65
    buffer_load_dwordx4 v11, s[20:23], s41 offen offset:1024 lds
    v_mfma_f32_16x16x32_bf16 v[48:51], v[100:103], v[120:123], v[48:51]
    ds_read2_b32 v[94:95], v18 offset0:66 offset1:67
    v_mfma_f32_16x16x32_bf16 v[52:55], v[100:103], v[136:139], v[52:55]
    v_mfma_f32_16x16x32_bf16 v[56:59], v[100:103], v[152:155], v[56:59]
    v_mfma_f32_16x16x32_bf16 v[60:63], v[100:103], v[168:171], v[60:63]
    v_mfma_f32_16x16x32_bf16 v[64:67], v[100:103], v[184:187], v[64:67]
    v_mfma_f32_16x16x32_bf16 v[68:71], v[100:103], v[200:203], v[68:71]
    v_lshrrev_b32 v4, 3, v1
    v_mul_u32_u24 v4, 229376, v4
    v_lshl_add_u32 v4, v6, 4, v4
    s_waitcnt vmcnt(10)
    s_lshl_b32 s36, s44, 7
    s_add_u32 s36, s36, 0x200000
    buffer_store_dwordx4 v[32:35], v4, s[16:19], s36 offen sc1
    s_lshl_b32 s36, s45, 7
    s_add_u32 s36, s36, 0x200000
    buffer_store_dwordx4 v[36:39], v4, s[16:19], s36 offen sc1
    s_waitcnt lgkmcnt(11)
    v_mfma_f32_16x16x32_bf16 v[48:51], v[72:75], v[116:119], v[48:51]
    ds_read2_b32 v[96:97], v18 offset0:32 offset1:33
    v_mfma_f32_16x16x32_bf16 v[52:55], v[72:75], v[132:135], v[52:55]
    ds_read2_b32 v[98:99], v18 offset0:34 offset1:35
    v_mfma_f32_16x16x32_bf16 v[56:59], v[72:75], v[148:151], v[56:59]
    buffer_load_dwordx4 v12, s[20:23], s41 offen offset:2048 lds
    s_add_u32 s41, s41, 229376
    s_cmp_eq_u32 s41, s99
    s_cselect_b32 s36, 1835008, 0
    s_sub_u32 s41, s41, s36
    v_mfma_f32_16x16x32_bf16 v[60:63], v[72:75], v[164:167], v[60:63]
    v_mfma_f32_16x16x32_bf16 v[64:67], v[72:75], v[180:183], v[64:67]
    v_mfma_f32_16x16x32_bf16 v[68:71], v[72:75], v[196:199], v[68:71]
    ds_write_b128 v23, v[44:47] offset:1024
    s_waitcnt vmcnt(6)
    s_cmp_lg_u32 s7, 0
    s_cbranch_scc1 L_nomod
    s_mov_b32 s51, 32768
    s_branch L_mp_chk
L_mp:
    s_sleep 1
L_mp_go:
    buffer_load_dwordx4 v[240:243], v15, s[16:19], s6 offen offset:0 sc1
    buffer_load_dwordx4 v[244:247], v15, s[16:19], s6 offen offset:1024 sc1
    s_waitcnt vmcnt(0)
L_mp_chk:
    v_cmp_ne_u32 vcc, s50, v242
    v_cmp_ne_u32 s[92:93], s50, v246
    s_sub_u32 s51, s51, 1
    s_cbranch_scc1 L_mp_ok
    s_or_b64 vcc, vcc, s[92:93]
    s_cbranch_vccnz L_mp
L_mp_ok:
L_nomod:
    s_waitcnt lgkmcnt(12)
    v_mfma_f32_16x16x32_bf16 v[48:51], v[76:79], v[112:115], v[48:51]
    ds_read2_b32 v[100:101], v18 offset0:0 offset1:1
    v_add_f32 v240, v240, v244
    v_add_f32 v241, v241, v245
    v_mfma_f32_16x16x32_bf16 v[52:55], v[76:79], v[128:131], v[52:55]
    v_mov_b32 v246, s50
    v_mov_b32 v247, s50
    v_mfma_f32_16x16x32_bf16 v[56:59], v[76:79], v[144:147], v[56:59]
    v_add_f32_dpp v240, v240, v240 row_ror:8 row_mask:0xf bank_mask:0xf
    v_add_f32_dpp v241, v241, v241 row_ror:8 row_mask:0xf bank_mask:0xf
    v_mfma_f32_16x16x32_bf16 v[60:63], v[76:79], v[160:163], v[60:63]
    v_mov_b32 v242, v240
    v_mov_b32 v243, v241
    v_mfma_f32_16x16x32_bf16 v[64:67], v[76:79], v[176:179], v[64:67]
    v_permlane16_swap_b32 v240, v242
    v_permlane16_swap_b32 v241, v243
    v_mfma_f32_16x16x32_bf16 v[68:71], v[76:79], v[192:195], v[68:71]
    v_add_f32 v240, v240, v242
    v_add_f32 v241, v241, v243
    s_add_u32 m0, s42, 18432
    s_nop 0
    buffer_load_dwordx4 v10, s[20:23], s41 offen offset:0 lds
    s_waitcnt lgkmcnt(11)
    v_mfma_f32_16x16x32_bf16 v[48:51], v[80:83], v[108:111], v[48:51]
    ds_read2_b32 v[102:103], v18 offset0:2 offset1:3
    v_mov_b32 v242, v240
    v_mov_b32 v243, v241
    v_mfma_f32_16x16x32_bf16 v[52:55], v[80:83], v[124:127], v[52:55]
    ds_read2_b32 v[72:73], v17 offset0:224 offset1:225
    v_permlane32_swap_b32 v240, v242
    v_permlane32_swap_b32 v241, v243
    v_mfma_f32_16x16x32_bf16 v[56:59], v[80:83], v[140:143], v[56:59]
    v_add_f32 v240, v240, v242
    v_add_f32 v241, v241, v243
    v_mfma_f32_16x16x32_bf16 v[60:63], v[80:83], v[156:159], v[60:63]
    v_cvt_pk_bf16_f32 v242, v240, v241
    v_lshlrev_b32 v243, 3, v1
    v_mfma_f32_16x16x32_bf16 v[64:67], v[80:83], v[172:175], v[64:67]
    v_lshlrev_b32 v240, 16, v242
    v_and_b32 v241, s40, v242
    v_mfma_f32_16x16x32_bf16 v[68:71], v[80:83], v[188:191], v[68:71]
    v_add_f32 v240, s4, v240
    v_add_f32 v241, s4, v241
    s_waitcnt lgkmcnt(10)
    v_mfma_f32_16x16x32_bf16 v[48:51], v[84:87], v[104:107], v[48:51]
    ds_read2_b32 v[74:75], v17 offset0:226 offset1:227
    v_cvt_pk_bf16_f32 v244, v240, v241
    v_mfma_f32_16x16x32_bf16 v[52:55], v[84:87], v[120:123], v[52:55]
    ds_read2_b32 v[76:77], v17 offset0:192 offset1:193
    v_mov_b32_dpp v245, v244 quad_perm:[1,1,3,3] row_mask:0xf bank_mask:0xf
    v_mfma_f32_16x16x32_bf16 v[56:59], v[84:87], v[136:139], v[56:59]
    ds_read2_b32 v[78:79], v17 offset0:194 offset1:195
    s_mov_b64 exec, 0x55
    buffer_store_dwordx4 v[244:247], v243, s[16:19], s5 offen sc1
    s_mov_b64 exec, -1
    buffer_load_dwordx4 v11, s[20:23], s41 offen offset:1024 lds
    v_mfma_f32_16x16x32_bf16 v[60:63], v[84:87], v[152:155], v[60:63]
    v_mfma_f32_16x16x32_bf16 v[64:67], v[84:87], v[168:171], v[64:67]
    v_mfma_f32_16x16x32_bf16 v[68:71], v[84:87], v[184:187], v[68:71]
    s_waitcnt lgkmcnt(11)
    v_mfma_f32_16x16x32_bf16 v[52:55], v[88:91], v[116:119], v[52:55]
    ds_read2_b32 v[80:81], v17 offset0:160 offset1:161
    v_mfma_f32_16x16x32_bf16 v[56:59], v[88:91], v[132:135], v[56:59]
    ds_read2_b32 v[82:83], v17 offset0:162 offset1:163
    v_mfma_f32_16x16x32_bf16 v[60:63], v[88:91], v[148:151], v[60:63]
    v_mfma_f32_16x16x32_bf16 v[64:67], v[88:91], v[164:167], v[64:67]
    v_mfma_f32_16x16x32_bf16 v[68:71], v[88:91], v[180:183], v[68:71]
    ds_write_b128 v23, v[48:51] offset:2048
    s_waitcnt lgkmcnt(12)
    v_mfma_f32_16x16x32_bf16 v[52:55], v[92:95], v[112:115], v[52:55]
    ds_read2_b32 v[84:85], v17 offset0:128 offset1:129
    buffer_load_dwordx4 v12, s[20:23], s41 offen offset:2048 lds
    s_add_u32 s41, s41, 229376
    s_cmp_eq_u32 s41, s99
    s_cselect_b32 s36, 1835008, 0
    s_sub_u32 s41, s41, s36
    v_mfma_f32_16x16x32_bf16 v[56:59], v[92:95], v[128:131], v[56:59]
    v_mfma_f32_16x16x32_bf16 v[60:63], v[92:95], v[144:147], v[60:63]
    v_mfma_f32_16x16x32_bf16 v[64:67], v[92:95], v[160:163], v[64:67]
    v_mfma_f32_16x16x32_bf16 v[68:71], v[92:95], v[176:179], v[68:71]
    s_waitcnt lgkmcnt(11)
    v_mfma_f32_16x16x32_bf16 v[52:55], v[96:99], v[108:111], v[52:55]
    ds_read2_b32 v[86:87], v17 offset0:130 offset1:131
    v_mfma_f32_16x16x32_bf16 v[56:59], v[96:99], v[124:127], v[56:59]
    ds_read2_b32 v[88:89], v17 offset0:96 offset1:97
    v_mfma_f32_16x16x32_bf16 v[60:63], v[96:99], v[140:143], v[60:63]
    v_mfma_f32_16x16x32_bf16 v[64:67], v[96:99], v[156:159], v[64:67]
    v_mfma_f32_16x16x32_bf16 v[68:71], v[96:99], v[172:175], v[68:71]
    s_add_u32 m0, s42, 24576
    s_nop 0
    buffer_load_dwordx4 v10, s[20:23], s41 offen offset:0 lds
    s_waitcnt lgkmcnt(10)
    v_mfma_f32_16x16x32_bf16 v[52:55], v[100:103], v[104:107], v[52:55]
    ds_read2_b32 v[90:91], v17 offset0:98 offset1:99
    v_mfma_f32_16x16x32_bf16 v[56:59], v[100:103], v[120:123], v[56:59]
    ds_read2_b32 v[92:93], v17 offset0:64 offset1:65
    v_mfma_f32_16x16x32_bf16 v[60:63], v[100:103], v[136:139], v[60:63]
    ds_read2_b32 v[94:95], v17 offset0:66 offset1:67
    v_mfma_f32_16x16x32_bf16 v[64:67], v[100:103], v[152:155], v[64:67]
    v_mfma_f32_16x16x32_bf16 v[68:71], v[100:103], v[168:171], v[68:71]
    s_waitcnt lgkmcnt(11)
    v_mfma_f32_16x16x32_bf16 v[56:59], v[72:75], v[116:119], v[56:59]
    ds_read2_b32 v[96:97], v17 offset0:32 offset1:33
    v_mfma_f32_16x16x32_bf16 v[60:63], v[72:75], v[132:135], v[60:63]
    ds_read2_b32 v[98:99], v17 offset0:34 offset1:35
    v_mfma_f32_16x16x32_bf16 v[64:67], v[72:75], v[148:151], v[64:67]
    v_mfma_f32_16x16x32_bf16 v[68:71], v[72:75], v[164:167], v[68:71]
    buffer_load_dwordx4 v11, s[20:23], s41 offen offset:1024 lds
    ds_write_b128 v23, v[52:55] offset:3072
    s_waitcnt lgkmcnt(12)
    v_mfma_f32_16x16x32_bf16 v[56:59], v[76:79], v[112:115], v[56:59]
    ds_read2_b32 v[100:101], v17 offset0:0 offset1:1
    v_mfma_f32_16x16x32_bf16 v[60:63], v[76:79], v[128:131], v[60:63]
    v_mfma_f32_16x16x32_bf16 v[64:67], v[76:79], v[144:147], v[64:67]
    v_mfma_f32_16x16x32_bf16 v[68:71], v[76:79], v[160:163], v[68:71]
    s_waitcnt lgkmcnt(11)
    v_mfma_f32_16x16x32_bf16 v[56:59], v[80:83], v[108:111], v[56:59]
    ds_read2_b32 v[102:103], v17 offset0:2 offset1:3
    v_mfma_f32_16x16x32_bf16 v[60:63], v[80:83], v[124:127], v[60:63]
    ds_read2_b32 v[72:73], v16 offset0:224 offset1:225
    v_mfma_f32_16x16x32_bf16 v[64:67], v[80:83], v[140:143], v[64:67]
    v_mfma_f32_16x16x32_bf16 v[68:71], v[80:83], v[156:159], v[68:71]
    s_waitcnt lgkmcnt(10)
    v_mfma_f32_16x16x32_bf16 v[56:59], v[84:87], v[104:107], v[56:59]
    ds_read2_b32 v[74:75], v16 offset0:226 offset1:227
    buffer_load_dwordx4 v12, s[20:23], s41 offen offset:2048 lds
    s_add_u32 s41, s41, 229376
    s_cmp_eq_u32 s41, s99
    s_cselect_b32 s36, 1835008, 0
    s_sub_u32 s41, s41, s36
    v_mfma_f32_16x16x32_bf16 v[60:63], v[84:87], v[120:123], v[60:63]
    ds_read2_b32 v[76:77], v16 offset0:192 offset1:193
    v_mfma_f32_16x16x32_bf16 v[64:67], v[84:87], v[136:139], v[64:67]
    ds_read2_b32 v[78:79], v16 offset0:194 offset1:195
    v_mfma_f32_16x16x32_bf16 v[68:71], v[84:87], v[152:155], v[68:71]
    s_waitcnt lgkmcnt(11)
    v_mfma_f32_16x16x32_bf16 v[60:63], v[88:91], v[116:119], v[60:63]
    ds_read2_b32 v[80:81], v16 offset0:160 offset1:161
    v_mfma_f32_16x16x32_bf16 v[64:67], v[88:91], v[132:135], v[64:67]
    ds_read2_b32 v[82:83], v16 offset0:162 offset1:163
    v_mfma_f32_16x16x32_bf16 v[68:71], v[88:91], v[148:151], v[68:71]
    ds_write_b128 v23, v[56:59] offset:4096
    s_waitcnt vmcnt(8)
    s_waitcnt lgkmcnt(9)
    s_barrier
    v_mfma_f32_16x16x32_bf16 v[60:63], v[92:95], v[112:115], v[60:63]
    ds_read2_b32 v[84:85], v16 offset0:128 offset1:129
    ds_read_b64 v[208:209], v2 offset:0
    ds_read_b64 v[210:211], v2 offset:8192
    v_mfma_f32_16x16x32_bf16 v[64:67], v[92:95], v[128:131], v[64:67]
    ds_read2_b32 v[86:87], v16 offset0:130 offset1:131
    ds_read_b64 v[212:213], v2 offset:16384
    v_mfma_f32_16x16x32_bf16 v[68:71], v[92:95], v[144:147], v[68:71]
    v_mfma_f32_16x16x32_bf16 v[60:63], v[96:99], v[108:111], v[60:63]
    v_mfma_f32_16x16x32_bf16 v[64:67], v[96:99], v[124:127], v[64:67]
    v_mfma_f32_16x16x32_bf16 v[68:71], v[96:99], v[140:143], v[68:71]
    s_waitcnt lgkmcnt(12)
    v_mfma_f32_16x16x32_bf16 v[60:63], v[100:103], v[104:107], v[60:63]
    ds_read2_b32 v[88:89], v16 offset0:96 offset1:97
    ds_read_b64 v[214:215], v2 offset:24576
    v_mfma_f32_16x16x32_bf16 v[64:67], v[100:103], v[120:123], v[64:67]
    v_mfma_f32_16x16x32_bf16 v[68:71], v[100:103], v[136:139], v[68:71]
    s_waitcnt lgkmcnt(12)
    v_mfma_f32_16x16x32_bf16 v[64:67], v[72:75], v[116:119], v[64:67]
    ds_read2_b32 v[90:91], v16 offset0:98 offset1:99
    ds_read_b64 v[216:217], v2 offset:2048
    v_mfma_f32_16x16x32_bf16 v[68:71], v[72:75], v[132:135], v[68:71]
    s_waitcnt lgkmcnt(12)
    v_mfma_f32_16x16x32_bf16 v[64:67], v[76:79], v[112:115], v[64:67]
    ds_read2_b32 v[92:93], v16 offset0:64 offset1:65
    ds_read_b64 v[218:219], v2 offset:10240
    v_mfma_f32_16x16x32_bf16 v[68:71], v[76:79], v[128:131], v[68:71]
    s_waitcnt lgkmcnt(12)
    v_mfma_f32_16x16x32_bf16 v[64:67], v[80:83], v[108:111], v[64:67]
    ds_read2_b32 v[94:95], v16 offset0:66 offset1:67
    ds_read_b64 v[220:221], v2 offset:18432
    v_mfma_f32_16x16x32_bf16 v[68:71], v[80:83], v[124:127], v[68:71]
    s_waitcnt lgkmcnt(9)
    v_mfma_f32_16x16x32_bf16 v[64:67], v[84:87], v[104:107], v[64:67]
    ds_read2_b32 v[96:97], v16 offset0:32 offset1:33
    ds_read_b64 v[222:223], v2 offset:26624
    v_mov_b32 v202, s50
    v_mfma_f32_16x16x32_bf16 v[68:71], v[84:87], v[120:123], v[68:71]
    ds_read2_b32 v[98:99], v16 offset0:34 offset1:35
    v_mov_b32 v203, s50
    s_waitcnt lgkmcnt(9)
    v_add_f32 v208, v208, v210
    ds_write_b128 v23, v[60:63] offset:5120
    s_waitcnt lgkmcnt(9)
    v_mfma_f32_16x16x32_bf16 v[68:71], v[88:91], v[116:119], v[68:71]
    ds_read2_b32 v[100:101], v16 offset0:0 offset1:1
    v_add_f32 v212, v212, v214
    v_add_f32 v209, v209, v211
    ds_write_b128 v23, v[64:67] offset:6144
    s_waitcnt lgkmcnt(7)
    v_mfma_f32_16x16x32_bf16 v[68:71], v[92:95], v[112:115], v[68:71]
    ds_read2_b32 v[102:103], v16 offset0:2 offset1:3
    v_add_f32 v213, v213, v215
    v_cvt_pk_bf16_f32 v200, v208, v212
    s_waitcnt lgkmcnt(4)
    v_mfma_f32_16x16x32_bf16 v[68:71], v[96:99], v[108:111], v[68:71]
    v_cvt_pk_bf16_f32 v201, v209, v213
    buffer_store_dwordx4 v[200:203], v3, s[16:19], s38 offen sc1
    s_add_u32 s38, s38, 0x1000
    s_waitcnt lgkmcnt(0)
    v_mfma_f32_16x16x32_bf16 v[68:71], v[100:103], v[104:107], v[68:71]
    v_mov_b32 v206, s50
    v_mov_b32 v207, s50
    s_nop 5
    ds_write_b128 v23, v[68:71] offset:7168
    s_waitcnt lgkmcnt(0)
    v_add_f32 v216, v216, v218
    v_add_f32 v220, v220, v222
    v_add_f32 v217, v217, v219
    v_add_f32 v221, v221, v223
    v_cvt_pk_bf16_f32 v204, v216, v220
    v_cvt_pk_bf16_f32 v205, v217, v221
    buffer_store_dwordx4 v[204:207], v3, s[16:19], s38 offen sc1
    s_add_u32 s38, s38, 0x1000
    v_lshlrev_b32 v4, 3, v0
    v_add_u32 v4, 157184, v4
    v_and_b32 v5, 3, v0
    v_add_u32 v13, 157184, v15
    s_and_b32 s36, s32, 7
    s_xor_b32 s36, s36, 3
    s_lshl_b32 s36, s36, 1
    s_and_b32 s37, s3, 1
    s_or_b32 s36, s36, s37
    s_lshl_b32 s36, s36, 6
    s_add_u32 s36, s36, 162304
    v_lshrrev_b32 v14, 5, v1
    v_lshl_add_u32 v14, v14, 4, s36
    s_waitcnt lgkmcnt(0)
    s_barrier
    ds_read_b64 v[88:89], v2 offset:4096
    ds_read_b64 v[90:91], v2 offset:12288
    ds_read_b64 v[92:93], v2 offset:20480
    ds_read_b64 v[94:95], v2 offset:28672
    ds_read_b64 v[96:97], v2 offset:6144
    ds_read_b64 v[98:99], v2 offset:14336
    ds_read_b64 v[100:101], v2 offset:22528
    ds_read_b64 v[102:103], v2 offset:30720
    s_lshl_b32 s35, s3, 10
    s_add_u32 s35, s35, 0x1400000
    s_add_u32 s34, s35, 4096
    s_add_u32 s4, s35, 8192
    v_mov_b32 v34, s50
    v_mov_b32 v35, s50
    s_waitcnt lgkmcnt(4)
    v_pk_add_f32 v[88:89], v[88:89], v[90:91]
    v_pk_add_f32 v[92:93], v[92:93], v[94:95]
    v_cvt_pk_bf16_f32 v32, v88, v92
    v_cvt_pk_bf16_f32 v33, v89, v93
    buffer_store_dwordx4 v[32:35], v3, s[16:19], s38 offen sc1
    s_add_u32 s38, s38, 0x1000
    v_mov_b32 v38, s50
    v_mov_b32 v39, s50
    s_waitcnt lgkmcnt(0)
    v_pk_add_f32 v[96:97], v[96:97], v[98:99]
    v_pk_add_f32 v[100:101], v[100:101], v[102:103]
    v_cvt_pk_bf16_f32 v36, v96, v100
    v_cvt_pk_bf16_f32 v37, v97, v101
    buffer_store_dwordx4 v[36:39], v3, s[16:19], s38 offen sc1
    v_mov_b32 v22, v4
    v_mov_b32 v23, v14
    v_mov_b32 v60, v5
    v_mov_b32 v5, v60
    buffer_load_dwordx4 v[104:107], v15, s[16:19], s35 offen sc1
    buffer_load_dwordx4 v[108:111], v15, s[16:19], s34 offen sc1
    buffer_load_dwordx4 v[112:115], v15, s[16:19], s4 offen sc1
    v_lshrrev_b32 v14, 2, v0
    v_mul_u32_u24 v14, 16512, v14
    v_and_b32 v19, 3, v0
    v_lshl_add_u32 v14, v19, 4, v14
    s_lshl_b32 s24, s32, 6
    s_add_u32 s26, s24, 0x400000
    s_add_u32 s27, s26, 1056768
    s_add_u32 s5, s26, 2113536
    s_add_u32 s6, s26, 3170304
    s_add_u32 m0, s42, 30720
    s_nop 0
    buffer_load_dwordx4 v10, s[20:23], s41 offen offset:0 lds
    buffer_load_dwordx4 v11, s[20:23], s41 offen offset:1024 lds
    buffer_load_dwordx4 v12, s[20:23], s41 offen offset:2048 lds
    s_add_u32 s41, s41, 229376
    s_cmp_eq_u32 s41, s99
    s_cselect_b32 s36, 1835008, 0
    s_sub_u32 s41, s41, s36
    s_add_u32 m0, s42, 36864
    s_nop 0
    buffer_load_dwordx4 v10, s[20:23], s41 offen offset:0 lds
    buffer_load_dwordx4 v11, s[20:23], s41 offen offset:1024 lds
    buffer_load_dwordx4 v12, s[20:23], s41 offen offset:2048 lds
    s_add_u32 s41, s41, 229376
    s_cmp_eq_u32 s41, s99
    s_cselect_b32 s36, 1835008, 0
    s_sub_u32 s41, s41, s36
    v_lshrrev_b32 v4, 2, v0
    v_mul_u32_u24 v3, 2080, v5
    v_lshl_add_u32 v3, v4, 2, v3
    v_add_u32 v3, 143488, v3
    s_mul_i32 s46, s3, 2080
    s_add_u32 s46, s46, 143488
    v_add_u32 v4, s46, v15
    s_lshl_b32 s46, s3, 1
    v_xor_b32 v5, s46, v6
    v_lshlrev_b32 v5, 4, v5
    v_lshl_add_u32 v5, v1, 7, v5
    v_add_u32 v5, 151808, v5
    v_xor_b32 v16, 16, v5
    v_lshrrev_b32 v17, 3, v1
    v_xor_b32 v18, v17, v6
    v_lshlrev_b32 v18, 4, v18
    v_lshl_add_u32 v18, v17, 7, v18
    s_lshl_b32 s46, s3, 11
    s_add_u32 s46, s46, 151808
    v_add_u32 v18, s46, v18
    v_lshlrev_b32 v17, 9, v17
    v_lshl_add_u32 v17, v6, 4, v17
    s_lshr_b32 s46, s32, 2
    s_lshl_b32 s46, s46, 15
    s_and_b32 s47, s32, 3
    s_lshl_b32 s47, s47, 7
    s_add_u32 s46, s46, s47
    s_lshl_b32 s47, s3, 13
    s_add_u32 s46, s46, s47
    s_add_u32 s46, s46, 0x0
    s_add_u32 s47, s46, 0x1000
    s_mov_b32 s12, s56
    s_mov_b32 s13, s57
    s_mov_b32 s14, 0x200000
    s_add_u32 s37, s33, 0
    v_lshlrev_b32 v64, 16, v232
    v_lshlrev_b32 v160, 16, v236
    v_and_b32 v65, s40, v232
    v_and_b32 v161, s40, v236
    v_lshlrev_b32 v66, 16, v233
    v_lshlrev_b32 v162, 16, v237
    v_and_b32 v67, s40, v233
    v_and_b32 v163, s40, v237
    v_lshlrev_b32 v68, 16, v234
    v_lshlrev_b32 v164, 16, v238
    v_and_b32 v69, s40, v234
    v_and_b32 v165, s40, v238
    v_lshlrev_b32 v70, 16, v235
    v_lshlrev_b32 v166, 16, v239
    v_and_b32 v71, s40, v235
    v_and_b32 v167, s40, v239
    v_pk_add_f32 v[80:81], v[64:65], v[66:67]
    v_pk_add_f32 v[176:177], v[160:161], v[162:163]
    v_pk_add_f32 v[82:83], v[68:69], v[70:71]
    v_pk_add_f32 v[178:179], v[164:165], v[166:167]
    v_pk_add_f32 v[80:81], v[80:81], v[82:83]
    v_pk_add_f32 v[176:177], v[176:177], v[178:179]
    v_add_f32 v80, v80, v81
    v_add_f32 v176, v176, v177
    s_nop 0
    v_add_f32_dpp v80, v80, v80 row_shr:1 row_mask:0xf bank_mask:0xf bound_ctrl:1
    v_add_f32_dpp v176, v176, v176 row_shr:1 row_mask:0xf bank_mask:0xf bound_ctrl:1
    s_nop 0
    v_add_f32_dpp v80, v80, v80 row_shr:2 row_mask:0xf bank_mask:0xf bound_ctrl:1
    v_add_f32_dpp v176, v176, v176 row_shr:2 row_mask:0xf bank_mask:0xf bound_ctrl:1
    s_nop 0
    v_add_f32_dpp v80, v80, v80 row_shr:4 row_mask:0xf bank_mask:0xf bound_ctrl:1
    v_add_f32_dpp v176, v176, v176 row_shr:4 row_mask:0xf bank_mask:0xf bound_ctrl:1
    s_nop 0
    v_add_f32_dpp v80, v80, v80 row_shr:8 row_mask:0xf bank_mask:0xf bound_ctrl:1
    v_add_f32_dpp v176, v176, v176 row_shr:8 row_mask:0xf bank_mask:0xf bound_ctrl:1
    s_nop 0
    v_add_f32_dpp v80, v80, v80 row_bcast:15 row_mask:0xa bank_mask:0xf
    v_add_f32_dpp v176, v176, v176 row_bcast:15 row_mask:0xa bank_mask:0xf
    s_nop 0
    v_add_f32_dpp v80, v80, v80 row_bcast:31 row_mask:0xc bank_mask:0xf
    v_add_f32_dpp v176, v176, v176 row_bcast:31 row_mask:0xc bank_mask:0xf
    v_readlane_b32 s24, v80, 63
    v_readlane_b32 s25, v176, 63
    v_mov_b32 v80, 0xbb000000
    v_mov_b32 v176, 0xbb000000
    v_mul_f32 v80, s24, v80
    v_mul_f32 v176, s25, v176
    v_pk_add_f32 v[72:73], v[64:65], v[80:81] op_sel:[0,0] op_sel_hi:[1,0]
    v_pk_add_f32 v[168:169], v[160:161], v[176:177] op_sel:[0,0] op_sel_hi:[1,0]
    v_pk_add_f32 v[74:75], v[66:67], v[80:81] op_sel:[0,0] op_sel_hi:[1,0]
    v_pk_add_f32 v[170:171], v[162:163], v[176:177] op_sel:[0,0] op_sel_hi:[1,0]
    v_pk_add_f32 v[76:77], v[68:69], v[80:81] op_sel:[0,0] op_sel_hi:[1,0]
    v_pk_add_f32 v[172:173], v[164:165], v[176:177] op_sel:[0,0] op_sel_hi:[1,0]
    v_pk_add_f32 v[78:79], v[70:71], v[80:81] op_sel:[0,0] op_sel_hi:[1,0]
    v_pk_add_f32 v[174:175], v[166:167], v[176:177] op_sel:[0,0] op_sel_hi:[1,0]
    v_pk_mul_f32 v[80:81], v[72:73], v[72:73]
    v_pk_mul_f32 v[176:177], v[168:169], v[168:169]
    v_pk_fma_f32 v[80:81], v[74:75], v[74:75], v[80:81]
    v_pk_fma_f32 v[176:177], v[170:171], v[170:171], v[176:177]
    v_pk_fma_f32 v[80:81], v[76:77], v[76:77], v[80:81]
    v_pk_fma_f32 v[176:177], v[172:173], v[172:173], v[176:177]
    v_pk_fma_f32 v[80:81], v[78:79], v[78:79], v[80:81]
    v_pk_fma_f32 v[176:177], v[174:175], v[174:175], v[176:177]
    v_add_f32 v80, v80, v81
    v_add_f32 v176, v176, v177
    s_nop 0
    v_add_f32_dpp v80, v80, v80 row_shr:1 row_mask:0xf bank_mask:0xf bound_ctrl:1
    v_add_f32_dpp v176, v176, v176 row_shr:1 row_mask:0xf bank_mask:0xf bound_ctrl:1
    s_nop 0
    v_add_f32_dpp v80, v80, v80 row_shr:2 row_mask:0xf bank_mask:0xf bound_ctrl:1
    v_add_f32_dpp v176, v176, v176 row_shr:2 row_mask:0xf bank_mask:0xf bound_ctrl:1
    s_nop 0
    v_add_f32_dpp v80, v80, v80 row_shr:4 row_mask:0xf bank_mask:0xf bound_ctrl:1
    v_add_f32_dpp v176, v176, v176 row_shr:4 row_mask:0xf bank_mask:0xf bound_ctrl:1
    s_nop 0
    v_add_f32_dpp v80, v80, v80 row_shr:8 row_mask:0xf bank_mask:0xf bound_ctrl:1
    v_add_f32_dpp v176, v176, v176 row_shr:8 row_mask:0xf bank_mask:0xf bound_ctrl:1
    s_nop 0
    v_add_f32_dpp v80, v80, v80 row_bcast:15 row_mask:0xa bank_mask:0xf
    v_add_f32_dpp v176, v176, v176 row_bcast:15 row_mask:0xa bank_mask:0xf
    s_nop 0
    v_add_f32_dpp v80, v80, v80 row_bcast:31 row_mask:0xc bank_mask:0xf
    v_add_f32_dpp v176, v176, v176 row_bcast:31 row_mask:0xc bank_mask:0xf
    v_readlane_b32 s24, v80, 63
    v_readlane_b32 s25, v176, 63
    v_mov_b32 v80, 0x3b000000
    v_mov_b32 v176, 0x3b000000
    v_mov_b32 v81, 0x3727c5ac
    v_mov_b32 v177, 0x3727c5ac
    v_fmac_f32 v81, s24, v80
    v_fmac_f32 v177, s25, v176
    v_rsq_f32 v80, v81
    v_rsq_f32 v176, v177
    v_pk_mul_f32 v[72:73], v[72:73], v[80:81] op_sel:[0,0] op_sel_hi:[1,0]
    v_pk_mul_f32 v[168:169], v[168:169], v[176:177] op_sel:[0,0] op_sel_hi:[1,0]
    v_pk_mul_f32 v[74:75], v[74:75], v[80:81] op_sel:[0,0] op_sel_hi:[1,0]
    v_pk_mul_f32 v[170:171], v[170:171], v[176:177] op_sel:[0,0] op_sel_hi:[1,0]
    v_pk_mul_f32 v[76:77], v[76:77], v[80:81] op_sel:[0,0] op_sel_hi:[1,0]
    v_pk_mul_f32 v[172:173], v[172:173], v[176:177] op_sel:[0,0] op_sel_hi:[1,0]
    v_pk_mul_f32 v[78:79], v[78:79], v[80:81] op_sel:[0,0] op_sel_hi:[1,0]
    v_pk_mul_f32 v[174:175], v[174:175], v[176:177] op_sel:[0,0] op_sel_hi:[1,0]
    s_mov_b32 s51, 32768
    s_waitcnt vmcnt(6)
    s_branch L_md_chk
L_md:
    s_sleep 1
L_md_go:
    buffer_load_dwordx4 v[104:107], v15, s[16:19], s35 offen sc1
    buffer_load_dwordx4 v[108:111], v15, s[16:19], s34 offen sc1
    buffer_load_dwordx4 v[112:115], v15, s[16:19], s4 offen sc1
    s_waitcnt vmcnt(0)
L_md_chk:
    v_cmp_ne_u32 vcc, s50, v106
    v_cmp_ne_u32 s[92:93], s50, v110
    v_cmp_ne_u32 s[94:95], s50, v114
    s_sub_u32 s51, s51, 1
    s_cbranch_scc1 L_md_ok
    s_or_b64 vcc, vcc, s[92:93]
    s_or_b64 vcc, vcc, s[94:95]
    s_cbranch_vccnz L_md
L_md_ok:
    ds_write_b64 v22, v[104:105] offset:0
    ds_write_b64 v22, v[108:109] offset:2048
    ds_write_b64 v22, v[112:113] offset:4096
    s_waitcnt lgkmcnt(0)
    s_barrier
    ds_read_b128 v[40:43], v13 offset:1024
    ds_read_b128 v[44:47], v13 offset:0
    ds_read_b128 v[48:51], v13 offset:2048
    ds_read_b128 v[52:55], v13 offset:4096
    ds_read_b128 v[56:59], v13 offset:3072
    ds_read_b128 v[124:127], v23
    ds_read_b128 v[116:119], v23 offset:32
    s_waitcnt lgkmcnt(5)
    v_lshlrev_b32 v128, 16, v40
    v_and_b32 v129, s40, v40
    v_lshlrev_b32 v130, 16, v41
    v_and_b32 v131, s40, v41
    v_lshlrev_b32 v132, 16, v42
    v_and_b32 v133, s40, v42
    v_lshlrev_b32 v134, 16, v43
    v_and_b32 v135, s40, v43
    v_lshlrev_b32 v136, 16, v44
    v_and_b32 v137, s40, v44
    v_lshlrev_b32 v138, 16, v45
    v_and_b32 v139, s40, v45
    v_lshlrev_b32 v140, 16, v46
    v_and_b32 v141, s40, v46
    v_lshlrev_b32 v142, 16, v47
    v_and_b32 v143, s40, v47
    v_pk_fma_f32 v[72:73], v[72:73], v[128:129], v[136:137]
    v_pk_fma_f32 v[74:75], v[74:75], v[130:131], v[138:139]
    v_pk_fma_f32 v[76:77], v[76:77], v[132:133], v[140:141]
    v_pk_fma_f32 v[78:79], v[78:79], v[134:135], v[142:143]
    v_pk_fma_f32 v[168:169], v[168:169], v[128:129], v[136:137]
    v_pk_fma_f32 v[170:171], v[170:171], v[130:131], v[138:139]
    v_pk_fma_f32 v[172:173], v[172:173], v[132:133], v[140:141]
    v_pk_fma_f32 v[174:175], v[174:175], v[134:135], v[142:143]
    s_waitcnt lgkmcnt(4)
    v_lshlrev_b32 v144, 16, v48
    v_and_b32 v145, s40, v48
    v_lshlrev_b32 v146, 16, v49
    v_and_b32 v147, s40, v49
    v_lshlrev_b32 v148, 16, v50
    v_and_b32 v149, s40, v50
    v_lshlrev_b32 v150, 16, v51
    v_and_b32 v151, s40, v51
    v_pk_mul_f32 v[72:73], v[72:73], v[144:145]
    v_pk_mul_f32 v[74:75], v[74:75], v[146:147]
    v_pk_mul_f32 v[76:77], v[76:77], v[148:149]
    v_pk_mul_f32 v[78:79], v[78:79], v[150:151]
    v_pk_mul_f32 v[168:169], v[168:169], v[144:145]
    v_pk_mul_f32 v[170:171], v[170:171], v[146:147]
    v_pk_mul_f32 v[172:173], v[172:173], v[148:149]
    v_pk_mul_f32 v[174:175], v[174:175], v[150:151]
    s_waitcnt lgkmcnt(0)
    v_lshlrev_b32 v128, 16, v52
    v_and_b32 v129, s40, v52
    v_lshlrev_b32 v130, 16, v53
    v_and_b32 v131, s40, v53
    v_lshlrev_b32 v132, 16, v54
    v_and_b32 v133, s40, v54
    v_lshlrev_b32 v134, 16, v55
    v_and_b32 v135, s40, v55
    v_lshlrev_b32 v136, 16, v56
    v_and_b32 v137, s40, v56
    v_lshlrev_b32 v138, 16, v57
    v_and_b32 v139, s40, v57
    v_lshlrev_b32 v140, 16, v58
    v_and_b32 v141, s40, v58
    v_lshlrev_b32 v142, 16, v59
    v_and_b32 v143, s40, v59
    buffer_load_dwordx4 v[24:27], v14, s[16:19], s26 offen sc1
    buffer_load_dwordx4 v[28:31], v14, s[16:19], s27 offen sc1
    buffer_load_dwordx4 v[32:35], v14, s[16:19], s5 offen sc1
    buffer_load_dwordx4 v[36:39], v14, s[16:19], s6 offen sc1
    s_mov_b32 s51, 32768
    s_waitcnt vmcnt(0)
    s_branch L_yt_chk
L_yt:
    s_sleep 1
L_yt_go:
    buffer_load_dwordx4 v[24:27], v14, s[16:19], s26 offen sc1
    buffer_load_dwordx4 v[28:31], v14, s[16:19], s27 offen sc1
    buffer_load_dwordx4 v[32:35], v14, s[16:19], s5 offen sc1
    buffer_load_dwordx4 v[36:39], v14, s[16:19], s6 offen sc1
    s_waitcnt vmcnt(0)
L_yt_chk:
    v_cmp_ne_u32 vcc, s50, v26
    v_cmp_ne_u32 s[92:93], s50, v30
    v_cmp_ne_u32 s[94:95], s50, v34
    v_cmp_ne_u32 s[96:97], s50, v38
    s_sub_u32 s51, s51, 1
    s_cbranch_scc1 L_yt_ok
    s_or_b64 vcc, vcc, s[92:93]
    s_or_b64 vcc, vcc, s[94:95]
    s_or_b64 vcc, vcc, s[96:97]
    s_cbranch_vccnz L_yt
L_yt_ok:
    ds_write_b32 v3, v24 offset:0
    ds_write_b32 v3, v25 offset:1040
    ds_write_b32 v3, v28 offset:256
    ds_write_b32 v3, v29 offset:1296
    ds_write_b32 v3, v32 offset:512
    ds_write_b32 v3, v33 offset:1552
    ds_write_b32 v3, v36 offset:768
    ds_write_b32 v3, v37 offset:1808
    s_waitcnt lgkmcnt(0)
    s_barrier
    ds_read_b128 v[24:27], v4
    ds_read_b128 v[28:31], v4 offset:1040
    s_add_u32 s100, s48, 1835008
    s_mul_i32 s36, s98, 229376
    s_add_u32 s48, s48, s36
    s_add_u32 m0, s42, 43008
    s_nop 0
    buffer_load_dwordx4 v10, s[20:23], s41 offen offset:0 lds
    buffer_load_dwordx4 v11, s[20:23], s41 offen offset:1024 lds
    buffer_load_dwordx4 v12, s[20:23], s41 offen offset:2048 lds
    s_waitcnt lgkmcnt(0)
    v_lshlrev_b32 v84, 16, v24
    v_lshlrev_b32 v180, 16, v28
    v_and_b32 v85, s40, v24
    v_and_b32 v181, s40, v28
    v_lshlrev_b32 v86, 16, v25
    v_lshlrev_b32 v182, 16, v29
    v_and_b32 v87, s40, v25
    v_and_b32 v183, s40, v29
    v_lshlrev_b32 v88, 16, v26
    v_lshlrev_b32 v184, 16, v30
    v_and_b32 v89, s40, v26
    v_and_b32 v185, s40, v30
    v_lshlrev_b32 v90, 16, v27
    v_lshlrev_b32 v186, 16, v31
    v_and_b32 v91, s40, v27
    v_and_b32 v187, s40, v31
    v_pk_fma_f32 v[64:65], v[72:73], v[84:85], v[64:65]
    v_pk_fma_f32 v[160:161], v[168:169], v[180:181], v[160:161]
    v_pk_fma_f32 v[66:67], v[74:75], v[86:87], v[66:67]
    v_pk_fma_f32 v[162:163], v[170:171], v[182:183], v[162:163]
    v_pk_fma_f32 v[68:69], v[76:77], v[88:89], v[68:69]
    v_pk_fma_f32 v[164:165], v[172:173], v[184:185], v[164:165]
    v_pk_fma_f32 v[70:71], v[78:79], v[90:91], v[70:71]
    v_pk_fma_f32 v[166:167], v[174:175], v[186:187], v[166:167]
    v_cvt_pk_bf16_f32 v32, v64, v65
    v_cvt_pk_bf16_f32 v36, v160, v161
    v_cvt_pk_bf16_f32 v33, v66, v67
    v_cvt_pk_bf16_f32 v37, v162, v163
    v_cvt_pk_bf16_f32 v34, v68, v69
    v_cvt_pk_bf16_f32 v38, v164, v165
    v_cvt_pk_bf16_f32 v35, v70, v71
    v_cvt_pk_bf16_f32 v39, v166, v167
    buffer_store_dwordx4 v[32:35], v15, s[12:15], s37 offen offset:0 sc1
    buffer_store_dwordx4 v[36:39], v15, s[12:15], s37 offen offset:1024 sc1
    v_lshlrev_b32 v64, 16, v32
    v_lshlrev_b32 v160, 16, v36
    v_and_b32 v65, s40, v32
    v_and_b32 v161, s40, v36
    v_lshlrev_b32 v66, 16, v33
    v_lshlrev_b32 v162, 16, v37
    v_and_b32 v67, s40, v33
    v_and_b32 v163, s40, v37
    v_lshlrev_b32 v68, 16, v34
    v_lshlrev_b32 v164, 16, v38
    v_and_b32 v69, s40, v34
    v_and_b32 v165, s40, v38
    v_lshlrev_b32 v70, 16, v35
    v_lshlrev_b32 v166, 16, v39
    v_and_b32 v71, s40, v35
    v_and_b32 v167, s40, v39
    v_pk_add_f32 v[80:81], v[64:65], v[66:67]
    v_pk_add_f32 v[176:177], v[160:161], v[162:163]
    v_pk_mul_f32 v[82:83], v[64:65], v[64:65]
    v_pk_mul_f32 v[178:179], v[160:161], v[160:161]
    v_pk_add_f32 v[72:73], v[68:69], v[70:71]
    v_pk_add_f32 v[168:169], v[164:165], v[166:167]
    v_pk_fma_f32 v[82:83], v[66:67], v[66:67], v[82:83]
    v_pk_fma_f32 v[178:179], v[162:163], v[162:163], v[178:179]
    v_pk_fma_f32 v[82:83], v[68:69], v[68:69], v[82:83]
    v_pk_fma_f32 v[178:179], v[164:165], v[164:165], v[178:179]
    v_pk_fma_f32 v[82:83], v[70:71], v[70:71], v[82:83]
    v_pk_fma_f32 v[178:179], v[166:167], v[166:167], v[178:179]
    v_pk_add_f32 v[80:81], v[80:81], v[72:73]
    v_pk_add_f32 v[176:177], v[176:177], v[168:169]
    v_add_f32 v82, v82, v83
    v_add_f32 v178, v178, v179
    v_add_f32 v80, v80, v81
    v_add_f32 v176, v176, v177
    v_add_f32_dpp v82, v82, v82 row_shr:1 row_mask:0xf bank_mask:0xf bound_ctrl:1
    v_add_f32_dpp v178, v178, v178 row_shr:1 row_mask:0xf bank_mask:0xf bound_ctrl:1
    v_add_f32_dpp v80, v80, v80 row_shr:1 row_mask:0xf bank_mask:0xf bound_ctrl:1
    v_add_f32_dpp v176, v176, v176 row_shr:1 row_mask:0xf bank_mask:0xf bound_ctrl:1
    v_add_f32_dpp v82, v82, v82 row_shr:2 row_mask:0xf bank_mask:0xf bound_ctrl:1
    v_add_f32_dpp v178, v178, v178 row_shr:2 row_mask:0xf bank_mask:0xf bound_ctrl:1
    v_add_f32_dpp v80, v80, v80 row_shr:2 row_mask:0xf bank_mask:0xf bound_ctrl:1
    v_add_f32_dpp v176, v176, v176 row_shr:2 row_mask:0xf bank_mask:0xf bound_ctrl:1
    v_add_f32_dpp v82, v82, v82 row_shr:4 row_mask:0xf bank_mask:0xf bound_ctrl:1
    v_add_f32_dpp v178, v178, v178 row_shr:4 row_mask:0xf bank_mask:0xf bound_ctrl:1
    v_add_f32_dpp v80, v80, v80 row_shr:4 row_mask:0xf bank_mask:0xf bound_ctrl:1
    v_add_f32_dpp v176, v176, v176 row_shr:4 row_mask:0xf bank_mask:0xf bound_ctrl:1
    v_add_f32_dpp v82, v82, v82 row_shr:8 row_mask:0xf bank_mask:0xf bound_ctrl:1
    v_add_f32_dpp v178, v178, v178 row_shr:8 row_mask:0xf bank_mask:0xf bound_ctrl:1
    v_add_f32_dpp v80, v80, v80 row_shr:8 row_mask:0xf bank_mask:0xf bound_ctrl:1
    v_add_f32_dpp v176, v176, v176 row_shr:8 row_mask:0xf bank_mask:0xf bound_ctrl:1
    v_add_f32_dpp v82, v82, v82 row_bcast:15 row_mask:0xa bank_mask:0xf
    v_add_f32_dpp v178, v178, v178 row_bcast:15 row_mask:0xa bank_mask:0xf
    v_add_f32_dpp v80, v80, v80 row_bcast:15 row_mask:0xa bank_mask:0xf
    v_add_f32_dpp v176, v176, v176 row_bcast:15 row_mask:0xa bank_mask:0xf
    v_add_f32_dpp v82, v82, v82 row_bcast:31 row_mask:0xc bank_mask:0xf
    v_add_f32_dpp v178, v178, v178 row_bcast:31 row_mask:0xc bank_mask:0xf
    v_add_f32_dpp v80, v80, v80 row_bcast:31 row_mask:0xc bank_mask:0xf
    v_add_f32_dpp v176, v176, v176 row_bcast:31 row_mask:0xc bank_mask:0xf
    v_readlane_b32 s25, v82, 63
    v_readlane_b32 s27, v178, 63
    v_readlane_b32 s24, v80, 63
    v_readlane_b32 s26, v176, 63
    v_mov_b32 v81, 0x3b000000
    v_mov_b32 v177, 0x3b000000
    v_mov_b32 v83, 0x3727c5ac
    v_mov_b32 v179, 0x3727c5ac
    v_mul_f32 v80, s24, v81
    v_mul_f32 v176, s26, v177
    v_fmac_f32 v83, s25, v81
    v_fmac_f32 v179, s27, v177
    v_fma_f32 v82, -v80, v80, v83
    v_fma_f32 v178, -v176, v176, v179
    v_max_f32 v82, 0x3727c5ac, v82
    v_max_f32 v178, 0x3727c5ac, v178
    v_rsq_f32 v82, v82
    v_rsq_f32 v178, v178
    v_mul_f32 v83, v80, v82
    v_mul_f32 v179, v176, v178
    v_pk_fma_f32 v[72:73], v[64:65], v[82:83], v[82:83] op_sel:[0,0,1] op_sel_hi:[1,0,1] neg_lo:[0,0,1] neg_hi:[0,0,1]
    v_pk_fma_f32 v[168:169], v[160:161], v[178:179], v[178:179] op_sel:[0,0,1] op_sel_hi:[1,0,1] neg_lo:[0,0,1] neg_hi:[0,0,1]
    v_pk_fma_f32 v[74:75], v[66:67], v[82:83], v[82:83] op_sel:[0,0,1] op_sel_hi:[1,0,1] neg_lo:[0,0,1] neg_hi:[0,0,1]
    v_pk_fma_f32 v[170:171], v[162:163], v[178:179], v[178:179] op_sel:[0,0,1] op_sel_hi:[1,0,1] neg_lo:[0,0,1] neg_hi:[0,0,1]
    v_pk_fma_f32 v[76:77], v[68:69], v[82:83], v[82:83] op_sel:[0,0,1] op_sel_hi:[1,0,1] neg_lo:[0,0,1] neg_hi:[0,0,1]
    v_pk_fma_f32 v[172:173], v[164:165], v[178:179], v[178:179] op_sel:[0,0,1] op_sel_hi:[1,0,1] neg_lo:[0,0,1] neg_hi:[0,0,1]
    v_pk_fma_f32 v[78:79], v[70:71], v[82:83], v[82:83] op_sel:[0,0,1] op_sel_hi:[1,0,1] neg_lo:[0,0,1] neg_hi:[0,0,1]
    v_pk_fma_f32 v[174:175], v[166:167], v[178:179], v[178:179] op_sel:[0,0,1] op_sel_hi:[1,0,1] neg_lo:[0,0,1] neg_hi:[0,0,1]
    v_pk_fma_f32 v[72:73], v[72:73], v[128:129], v[136:137]
    v_pk_fma_f32 v[168:169], v[168:169], v[128:129], v[136:137]
    v_pk_fma_f32 v[74:75], v[74:75], v[130:131], v[138:139]
    v_pk_fma_f32 v[170:171], v[170:171], v[130:131], v[138:139]
    v_pk_fma_f32 v[76:77], v[76:77], v[132:133], v[140:141]
    v_pk_fma_f32 v[172:173], v[172:173], v[132:133], v[140:141]
    v_pk_fma_f32 v[78:79], v[78:79], v[134:135], v[142:143]
    v_pk_fma_f32 v[174:175], v[174:175], v[134:135], v[142:143]
    v_cvt_pk_bf16_f32 v40, v72, v73
    v_cvt_pk_bf16_f32 v44, v168, v169
    v_cvt_pk_bf16_f32 v41, v74, v75
    v_cvt_pk_bf16_f32 v45, v170, v171
    v_cvt_pk_bf16_f32 v42, v76, v77
    v_cvt_pk_bf16_f32 v46, v172, v173
    v_cvt_pk_bf16_f32 v43, v78, v79
    v_cvt_pk_bf16_f32 v47, v174, v175
    ds_write_b128 v5, v[40:43]
    ds_write_b128 v16, v[44:47]
    s_waitcnt lgkmcnt(0)
    s_barrier
    ds_read_b128 v[24:27], v18
    ds_read_b128 v[28:31], v18 offset:1024
    s_and_b32 s24, s32, 31
    s_lshl_b32 s24, s24, 4
    s_lshl_b32 s25, s3, 2
    s_add_u32 s33, s24, s25
    s_and_b32 s25, s30, 1
    s_lshl_b32 s25, s25, 8
    s_lshl_b32 s26, s3, 6
    s_add_u32 s25, s25, s26
    v_and_b32 v19, 15, v1
    v_lshlrev_b32 v19, 2, v19
    s_waitcnt lgkmcnt(0)
    s_cmp_eq_u32 s101, 0
    s_cbranch_scc1 L_ls1a
    buffer_store_dwordx4 v[24:27], v17, s[16:19], s46 offen sc1
    buffer_store_dwordx4 v[28:31], v17, s[16:19], s47 offen sc1
    s_branch L_ls1b
L_ls1a:
    buffer_store_dwordx4 v[24:27], v17, s[16:19], s46 offen
    buffer_store_dwordx4 v[28:31], v17, s[16:19], s47 offen
L_ls1b:
    v_bfe_u32 v4, v1, 4, 1
    v_lshrrev_b32 v5, 5, v1
    v_bfe_u32 v22, v1, 2, 2
    v_and_b32 v23, 3, v1
    v_lshlrev_b32 v23, 3, v23
    v_lshl_add_u32 v3, v5, 3, v22
    v_bfe_u32 v13, v1, 3, 1
    v_lshlrev_b32 v16, 7, v3
    v_add_u32 v16, v16, v23
    v_lshl_add_u32 v16, v13, 6, v16
    v_lshl_add_u32 v16, v4, 5, v16
    v_mul_u32_u24 v17, 30720, v4
    v_add_u32 v17, 98432, v17
    v_mul_u32_u24 v18, 49280, v4
    v_xor_b32 v14, 0, v16
    v_add_u32 v246, v14, v17
    v_add_u32 v120, v14, v18
    v_xor_b32 v14, 32, v16
    v_add_u32 v247, v14, v17
    v_add_u32 v121, v14, v18
    v_xor_b32 v14, 64, v16
    v_add_u32 v248, v14, v17
    v_add_u32 v122, v14, v18
    v_xor_b32 v14, 96, v16
    v_add_u32 v249, v14, v17
    v_add_u32 v123, v14, v18
    v_mul_u32_u24 v3, 0x60, v3
    v_add_u32 v3, v3, v23
    v_add_u32 v18, v18, v3
    v_lshl_add_u32 v3, v5, 2, v22
    v_lshlrev_b32 v3, 7, v3
    v_lshl_add_u32 v3, v13, 6, v3
    v_lshl_add_u32 v3, v4, 5, v3
    v_add_u32 v3, v3, v23
    s_lshl_b32 s26, s3, 11
    s_and_b32 s27, s3, 1
    s_lshl_b32 s27, s27, 6
    v_xor_b32 v3, s27, v3
    v_add_u32 v240, s26, v3
    v_xor_b32 v241, 64, v240
    v_add_u32 v242, 65536, v240
    v_add_u32 v243, 65536, v241
    v_add_u32 v244, 131072, v240
    v_add_u32 v245, 131072, v241
    s_mov_b32 s44, 0xbdd2d3e8
    s_mov_b32 s45, 0xbdd2d3e8
    v_mov_b32 v2, 0xc0135761
    v_mov_b32 v3, 0xc0135761
    s_lshl_b32 s27, s30, 2
    s_add_u32 s27, s27, s3
    s_lshl_b32 s28, s27, 15
    s_add_u32 s28, s28, 0x0
    v_add_u32 v14, s28, v15
    s_lshl_b32 s28, s98, 12
    s_waitcnt vmcnt(0)
    s_mov_b64 exec, 1
    s_cmp_eq_u32 s101, 0
    s_cbranch_scc1 L_ls2a
    buffer_store_dword v20, v21, s[52:55], s33 offen offset:1024 sc1
    s_branch L_ls2b
L_ls2a:
    buffer_store_dword v20, v21, s[52:55], s33 offen offset:1024
L_ls2b:
    s_mov_b64 exec, -1
    s_mul_i32 s29, s27, 112
    s_lshl_b32 s47, s31, 2
    s_add_u32 s47, s47, s29
    s_lshl_b32 s47, s47, 10
    s_add_u32 s47, s47, 0xd00000
    s_mul_i32 s46, s31, 3
    s_add_u32 s46, s46, s29
    s_lshl_b32 s46, s46, 10
    s_add_u32 s46, s46, 0xd10000
    s_lshr_b32 s39, s32, 3
    s_and_b32 s35, s39, 1
    s_and_b32 s34, s39, 0
    s_and_b32 s24, s32, 7
    s_xor_b32 s24, s24, 3
    s_lshl_b32 s24, s24, 7
    s_add_u32 s8, s58, 0x200000
    s_addc_u32 s9, s59, 0
    s_mul_i32 s24, s24, 1792
    s_mul_i32 s37, s3, 24576
    s_add_u32 s37, s37, s24
    s_add_u32 s30, s37, 155648
    s_mul_i32 s36, s34, 6144
    s_add_u32 s37, s37, s36
    s_add_u32 s37, s37, 131072
    s_mul_i32 s38, s3, 32768
    s_add_u32 s38, s38, s24
    s_add_u32 s31, s38, 32768
    s_mul_i32 s36, s34, 8192
    s_add_u32 s38, s38, s36
    s_mul_i32 s4, s39, 229376
    s_lshl_b32 s6, s3, 14
    s_add_u32 s6, s6, s4
    s_add_u32 s6, s6, 0xd00000
    s_add_u32 s42, s6, 16384
    s_mul_i32 s36, s34, 4096
    s_add_u32 s6, s6, s36
    s_mul_i32 s4, s39, 229376
    s_mul_i32 s5, s3, 12288
    s_add_u32 s5, s5, s4
    s_add_u32 s5, s5, 0xd10000
    s_add_u32 s41, s5, 12288
    s_mul_i32 s36, s34, 3072
    s_add_u32 s5, s5, s36
    s_lshl_b32 s39, s39, 16
    s_and_b32 s24, s32, 7
    s_xor_b32 s24, s24, 3
    s_lshl_b32 s24, s24, 7
    s_add_u32 s39, s39, s24
    v_bfe_u32 v4, v1, 1, 2
    v_and_b32 v5, 1, v1
    v_lshlrev_b32 v5, 2, v5
    v_lshl_add_u32 v4, v4, 4, v5
    s_lshl_b32 s35, s35, 3
    v_add_u32 v13, s35, v4
    s_cmp_ge_u32 s3, 2
    s_cselect_b32 s36, 114688, 0
    v_add_u32 v250, s36, v15
    s_cselect_b32 s36, 0, 114688
    v_add_u32 v16, s36, v15
    s_cselect_b32 s36, 114688, 0
    v_add_u32 v251, s36, v15
    s_cselect_b32 s36, 0, 114688
    v_add_u32 v17, s36, v15
    v_lshlrev_b32 v73, 7, v1
    s_lshl_b32 s34, s2, 2
    s_add_u32 s34, s34, s3
    s_mul_i32 s34, s34, 1792
    ds_read_b64_tr_b16 v[24:25], v18 offset:0
    ds_read_b64_tr_b16 v[26:27], v18 offset:384
    ds_read_b64_tr_b16 v[28:29], v18 offset:32
    ds_read_b64_tr_b16 v[30:31], v18 offset:416
    ds_read_b64_tr_b16 v[32:33], v18 offset:1536
    ds_read_b64_tr_b16 v[34:35], v18 offset:1920
    ds_read_b64_tr_b16 v[36:37], v18 offset:1568
    ds_read_b64_tr_b16 v[38:39], v18 offset:1952
    ds_read_b64_tr_b16 v[40:41], v18 offset:3072
    ds_read_b64_tr_b16 v[42:43], v18 offset:3456
    s_mov_b32 s51, 32768
    s_mov_b64 exec, 0xffff
    s_branch L_f1_go
L_f1:
    s_sleep 1
L_f1_go:
    buffer_load_dword v22, v19, s[52:55], s25 offen offset:1024 sc1
    s_waitcnt vmcnt(0)
L_f1_chk:
    v_cmp_ne_u32 vcc, s50, v22
    s_sub_u32 s51, s51, 1
    s_cbranch_scc1 L_f1_ok
    s_cbranch_vccnz L_f1
L_f1_ok:
    s_mov_b64 exec, -1
    buffer_load_dwordx4 a[0:3], v14, s[16:19], s28 offen offset:0 sc1
    buffer_load_dwordx4 a[4:7], v14, s[16:19], s28 offen offset:1024 sc1
    buffer_load_dwordx4 a[8:11], v14, s[16:19], s28 offen offset:2048 sc1
    buffer_load_dwordx4 a[12:15], v14, s[16:19], s28 offen offset:3072 sc1
    s_add_u32 s28, s28, 0x1000
    s_and_b32 s28, s28, 0x7fff
    buffer_load_dwordx4 a[16:19], v14, s[16:19], s28 offen offset:0 sc1
    buffer_load_dwordx4 a[20:23], v14, s[16:19], s28 offen offset:1024 sc1
    s_waitcnt vmcnt(5)
    s_waitcnt lgkmcnt(6)
    v_mfma_f32_32x32x16_bf16 v[192:207], v[24:27], a[0:3], 0
    ds_read_b64_tr_b16 v[44:45], v18 offset:3104
    ds_read_b64_tr_b16 v[46:47], v18 offset:3488
    v_mfma_f32_32x32x16_bf16 v[208:223], v[28:31], a[0:3], 0
    ds_read_b64_tr_b16 v[24:25], v18 offset:4608
    ds_read_b64_tr_b16 v[26:27], v18 offset:4992
    buffer_load_dwordx4 a[24:27], v14, s[16:19], s28 offen offset:2048 sc1
    s_waitcnt vmcnt(5)
    s_waitcnt lgkmcnt(6)
    v_mfma_f32_32x32x16_bf16 v[192:207], v[32:35], a[4:7], v[192:207]
    ds_read_b64_tr_b16 v[28:29], v18 offset:4640
    ds_read_b64_tr_b16 v[30:31], v18 offset:5024
    buffer_load_dwordx4 a[28:31], v14, s[16:19], s28 offen offset:3072 sc1
    s_add_u32 s28, s28, 0x1000
    s_and_b32 s28, s28, 0x7fff
    v_mfma_f32_32x32x16_bf16 v[208:223], v[36:39], a[4:7], v[208:223]
    ds_read_b64_tr_b16 v[32:33], v18 offset:6144
    ds_read_b64_tr_b16 v[34:35], v18 offset:6528
    s_waitcnt vmcnt(5)
    s_waitcnt lgkmcnt(6)
    v_mfma_f32_32x32x16_bf16 v[192:207], v[40:43], a[8:11], v[192:207]
    ds_read_b64_tr_b16 v[36:37], v18 offset:6176
    ds_read_b64_tr_b16 v[38:39], v18 offset:6560
    buffer_load_dwordx4 a[32:35], v14, s[16:19], s28 offen offset:0 sc1
    v_mfma_f32_32x32x16_bf16 v[208:223], v[44:47], a[8:11], v[208:223]
    ds_read_b64_tr_b16 v[40:41], v18 offset:7680
    ds_read_b64_tr_b16 v[42:43], v18 offset:8064
    buffer_load_dwordx4 a[36:39], v14, s[16:19], s28 offen offset:1024 sc1
    s_waitcnt vmcnt(6)
    s_waitcnt lgkmcnt(6)
    v_mfma_f32_32x32x16_bf16 v[192:207], v[24:27], a[12:15], v[192:207]
    ds_read_b64_tr_b16 v[44:45], v18 offset:7712
    ds_read_b64_tr_b16 v[46:47], v18 offset:8096
    v_mfma_f32_32x32x16_bf16 v[208:223], v[28:31], a[12:15], v[208:223]
    ds_read_b64_tr_b16 v[24:25], v18 offset:9216
    ds_read_b64_tr_b16 v[26:27], v18 offset:9600
    buffer_load_dwordx4 a[40:43], v14, s[16:19], s28 offen offset:2048 sc1
    s_waitcnt vmcnt(6)
    s_waitcnt lgkmcnt(6)
    v_mfma_f32_32x32x16_bf16 v[192:207], v[32:35], a[16:19], v[192:207]
    ds_read_b64_tr_b16 v[28:29], v18 offset:9248
    ds_read_b64_tr_b16 v[30:31], v18 offset:9632
    buffer_load_dwordx4 a[44:47], v14, s[16:19], s28 offen offset:3072 sc1
    s_add_u32 s28, s28, 0x1000
    s_and_b32 s28, s28, 0x7fff
    v_mfma_f32_32x32x16_bf16 v[208:223], v[36:39], a[16:19], v[208:223]
    ds_read_b64_tr_b16 v[32:33], v18 offset:10752
    ds_read_b64_tr_b16 v[34:35], v18 offset:11136
    s_waitcnt vmcnt(6)
    s_waitcnt lgkmcnt(6)
    v_mfma_f32_32x32x16_bf16 v[192:207], v[40:43], a[20:23], v[192:207]
    ds_read_b64_tr_b16 v[36:37], v18 offset:10784
    ds_read_b64_tr_b16 v[38:39], v18 offset:11168
    buffer_load_dwordx4 a[48:51], v14, s[16:19], s28 offen offset:0 sc1
    v_mfma_f32_32x32x16_bf16 v[208:223], v[44:47], a[20:23], v[208:223]
    ds_read_b64_tr_b16 v[40:41], v18 offset:12288
    ds_read_b64_tr_b16 v[42:43], v18 offset:12672
    buffer_load_dwordx4 a[52:55], v14, s[16:19], s28 offen offset:1024 sc1
    s_waitcnt vmcnt(7)
    s_waitcnt lgkmcnt(6)
    v_mfma_f32_32x32x16_bf16 v[192:207], v[24:27], a[24:27], v[192:207]
    ds_read_b64_tr_b16 v[44:45], v18 offset:12320
    ds_read_b64_tr_b16 v[46:47], v18 offset:12704
    v_mfma_f32_32x32x16_bf16 v[208:223], v[28:31], a[24:27], v[208:223]
    ds_read_b64_tr_b16 v[24:25], v18 offset:13824
    ds_read_b64_tr_b16 v[26:27], v18 offset:14208
    buffer_load_dwordx4 a[56:59], v14, s[16:19], s28 offen offset:2048 sc1
    s_waitcnt vmcnt(7)
    s_waitcnt lgkmcnt(6)
    v_mfma_f32_32x32x16_bf16 v[192:207], v[32:35], a[28:31], v[192:207]
    ds_read_b64_tr_b16 v[28:29], v18 offset:13856
    ds_read_b64_tr_b16 v[30:31], v18 offset:14240
    buffer_load_dwordx4 a[60:63], v14, s[16:19], s28 offen offset:3072 sc1
    s_add_u32 s28, s28, 0x1000
    s_and_b32 s28, s28, 0x7fff
    v_mfma_f32_32x32x16_bf16 v[208:223], v[36:39], a[28:31], v[208:223]
    ds_read_b64_tr_b16 v[32:33], v18 offset:15360
    ds_read_b64_tr_b16 v[34:35], v18 offset:15744
    s_waitcnt vmcnt(7)
    s_waitcnt lgkmcnt(6)
    v_mfma_f32_32x32x16_bf16 v[192:207], v[40:43], a[32:35], v[192:207]
    ds_read_b64_tr_b16 v[36:37], v18 offset:15392
    ds_read_b64_tr_b16 v[38:39], v18 offset:15776
    buffer_load_dwordx4 a[64:67], v14, s[16:19], s28 offen offset:0 sc1
    v_mfma_f32_32x32x16_bf16 v[208:223], v[44:47], a[32:35], v[208:223]
    ds_read_b64_tr_b16 v[40:41], v18 offset:16896
    ds_read_b64_tr_b16 v[42:43], v18 offset:17280
    buffer_load_dwordx4 a[68:71], v14, s[16:19], s28 offen offset:1024 sc1
    s_waitcnt vmcnt(8)
    s_waitcnt lgkmcnt(6)
    v_mfma_f32_32x32x16_bf16 v[192:207], v[24:27], a[36:39], v[192:207]
    ds_read_b64_tr_b16 v[44:45], v18 offset:16928
    ds_read_b64_tr_b16 v[46:47], v18 offset:17312
    v_mfma_f32_32x32x16_bf16 v[208:223], v[28:31], a[36:39], v[208:223]
    ds_read_b64_tr_b16 v[24:25], v18 offset:18432
    ds_read_b64_tr_b16 v[26:27], v18 offset:18816
    buffer_load_dwordx4 a[72:75], v14, s[16:19], s28 offen offset:2048 sc1
    s_waitcnt vmcnt(8)
    s_waitcnt lgkmcnt(6)
    v_mfma_f32_32x32x16_bf16 v[192:207], v[32:35], a[40:43], v[192:207]
    ds_read_b64_tr_b16 v[28:29], v18 offset:18464
    ds_read_b64_tr_b16 v[30:31], v18 offset:18848
    buffer_load_dwordx4 a[76:79], v14, s[16:19], s28 offen offset:3072 sc1
    s_add_u32 s28, s28, 0x1000
    s_and_b32 s28, s28, 0x7fff
    v_mfma_f32_32x32x16_bf16 v[208:223], v[36:39], a[40:43], v[208:223]
    ds_read_b64_tr_b16 v[32:33], v18 offset:19968
    ds_read_b64_tr_b16 v[34:35], v18 offset:20352
    s_waitcnt vmcnt(8)
    s_waitcnt lgkmcnt(6)
    v_mfma_f32_32x32x16_bf16 v[192:207], v[40:43], a[44:47], v[192:207]
    ds_read_b64_tr_b16 v[36:37], v18 offset:20000
    ds_read_b64_tr_b16 v[38:39], v18 offset:20384
    buffer_load_dwordx4 a[80:83], v14, s[16:19], s28 offen offset:0 sc1
    v_mfma_f32_32x32x16_bf16 v[208:223], v[44:47], a[44:47], v[208:223]
    ds_read_b64_tr_b16 v[40:41], v18 offset:21504
    ds_read_b64_tr_b16 v[42:43], v18 offset:21888
    buffer_load_dwordx4 a[84:87], v14, s[16:19], s28 offen offset:1024 sc1
    s_waitcnt vmcnt(9)
    s_waitcnt lgkmcnt(6)
    v_mfma_f32_32x32x16_bf16 v[192:207], v[24:27], a[48:51], v[192:207]
    ds_read_b64_tr_b16 v[44:45], v18 offset:21536
    ds_read_b64_tr_b16 v[46:47], v18 offset:21920
    v_mfma_f32_32x32x16_bf16 v[208:223], v[28:31], a[48:51], v[208:223]
    ds_read_b64_tr_b16 v[24:25], v18 offset:23040
    ds_read_b64_tr_b16 v[26:27], v18 offset:23424
    buffer_load_dwordx4 a[88:91], v14, s[16:19], s28 offen offset:2048 sc1
    s_waitcnt vmcnt(9)
    s_waitcnt lgkmcnt(6)
    v_mfma_f32_32x32x16_bf16 v[192:207], v[32:35], a[52:55], v[192:207]
    ds_read_b64_tr_b16 v[28:29], v18 offset:23072
    ds_read_b64_tr_b16 v[30:31], v18 offset:23456
    buffer_load_dwordx4 a[92:95], v14, s[16:19], s28 offen offset:3072 sc1
    s_add_u32 s28, s28, 0x1000
    s_and_b32 s28, s28, 0x7fff
    v_mfma_f32_32x32x16_bf16 v[208:223], v[36:39], a[52:55], v[208:223]
    ds_read_b64_tr_b16 v[32:33], v18 offset:24576
    ds_read_b64_tr_b16 v[34:35], v18 offset:24960
    s_waitcnt vmcnt(9)
    s_waitcnt lgkmcnt(6)
    v_mfma_f32_32x32x16_bf16 v[192:207], v[40:43], a[56:59], v[192:207]
    ds_read_b64_tr_b16 v[36:37], v18 offset:24608
    ds_read_b64_tr_b16 v[38:39], v18 offset:24992
    buffer_load_dwordx4 a[96:99], v14, s[16:19], s28 offen offset:0 sc1
    v_mfma_f32_32x32x16_bf16 v[208:223], v[44:47], a[56:59], v[208:223]
    ds_read_b64_tr_b16 v[40:41], v18 offset:26112
    ds_read_b64_tr_b16 v[42:43], v18 offset:26496
    buffer_load_dwordx4 a[100:103], v14, s[16:19], s28 offen offset:1024 sc1
    s_waitcnt vmcnt(10)
    s_waitcnt lgkmcnt(6)
    v_mfma_f32_32x32x16_bf16 v[192:207], v[24:27], a[60:63], v[192:207]
    ds_read_b64_tr_b16 v[44:45], v18 offset:26144
    ds_read_b64_tr_b16 v[46:47], v18 offset:26528
    v_mfma_f32_32x32x16_bf16 v[208:223], v[28:31], a[60:63], v[208:223]
    ds_read_b64_tr_b16 v[24:25], v18 offset:27648
    ds_read_b64_tr_b16 v[26:27], v18 offset:28032
    s_barrier
    buffer_load_dwordx4 a[104:107], v14, s[16:19], s28 offen offset:2048 sc1
    s_waitcnt vmcnt(10)
    s_waitcnt lgkmcnt(6)
    v_mfma_f32_32x32x16_bf16 v[192:207], v[32:35], a[64:67], v[192:207]
    ds_read_b64_tr_b16 v[28:29], v18 offset:27680
    ds_read_b64_tr_b16 v[30:31], v18 offset:28064
    buffer_load_dwordx4 a[108:111], v14, s[16:19], s28 offen offset:3072 sc1
    s_add_u32 s28, s28, 0x1000
    s_and_b32 s28, s28, 0x7fff
    v_mfma_f32_32x32x16_bf16 v[208:223], v[36:39], a[64:67], v[208:223]
    ds_read_b64_tr_b16 v[32:33], v18 offset:29184
    ds_read_b64_tr_b16 v[34:35], v18 offset:29568
    s_waitcnt vmcnt(10)
    s_waitcnt lgkmcnt(6)
    v_mfma_f32_32x32x16_bf16 v[192:207], v[40:43], a[68:71], v[192:207]
    ds_read_b64_tr_b16 v[36:37], v18 offset:29216
    ds_read_b64_tr_b16 v[38:39], v18 offset:29600
    buffer_load_dwordx4 a[112:115], v14, s[16:19], s28 offen offset:0 sc1
    v_mfma_f32_32x32x16_bf16 v[208:223], v[44:47], a[68:71], v[208:223]
    ds_read_b64_tr_b16 v[40:41], v18 offset:30720
    ds_read_b64_tr_b16 v[42:43], v18 offset:31104
    buffer_load_dwordx4 a[116:119], v14, s[16:19], s28 offen offset:1024 sc1
    s_waitcnt vmcnt(11)
    s_waitcnt lgkmcnt(6)
    v_mfma_f32_32x32x16_bf16 v[192:207], v[24:27], a[72:75], v[192:207]
    ds_read_b64_tr_b16 v[44:45], v18 offset:30752
    ds_read_b64_tr_b16 v[46:47], v18 offset:31136
    v_mfma_f32_32x32x16_bf16 v[208:223], v[28:31], a[72:75], v[208:223]
    ds_read_b64_tr_b16 v[24:25], v18 offset:32256
    ds_read_b64_tr_b16 v[26:27], v18 offset:32640
    buffer_load_dwordx4 a[120:123], v14, s[16:19], s28 offen offset:2048 sc1
    s_waitcnt vmcnt(11)
    s_waitcnt lgkmcnt(6)
    v_mfma_f32_32x32x16_bf16 v[192:207], v[32:35], a[76:79], v[192:207]
    ds_read_b64_tr_b16 v[28:29], v18 offset:32288
    ds_read_b64_tr_b16 v[30:31], v18 offset:32672
    buffer_load_dwordx4 a[124:127], v14, s[16:19], s28 offen offset:3072 sc1
    s_add_u32 s28, s28, 0x1000
    s_and_b32 s28, s28, 0x7fff
    v_mfma_f32_32x32x16_bf16 v[208:223], v[36:39], a[76:79], v[208:223]
    ds_read_b64_tr_b16 v[32:33], v18 offset:33792
    ds_read_b64_tr_b16 v[34:35], v18 offset:34176
    s_waitcnt vmcnt(11)
    s_waitcnt lgkmcnt(6)
    v_mfma_f32_32x32x16_bf16 v[192:207], v[40:43], a[80:83], v[192:207]
    ds_read_b64_tr_b16 v[36:37], v18 offset:33824
    ds_read_b64_tr_b16 v[38:39], v18 offset:34208
    s_add_u32 m0, s49, 98432
    s_nop 0
    buffer_load_dwordx4 v7, s[20:23], s48 offen lds
    v_mfma_f32_32x32x16_bf16 v[208:223], v[44:47], a[80:83], v[208:223]
    ds_read_b64_tr_b16 v[40:41], v18 offset:35328
    ds_read_b64_tr_b16 v[42:43], v18 offset:35712
    s_waitcnt vmcnt(11)
    s_waitcnt lgkmcnt(6)
    v_mfma_f32_32x32x16_bf16 v[192:207], v[24:27], a[84:87], v[192:207]
    ds_read_b64_tr_b16 v[44:45], v18 offset:35360
    ds_read_b64_tr_b16 v[46:47], v18 offset:35744
    v_mfma_f32_32x32x16_bf16 v[208:223], v[28:31], a[84:87], v[208:223]
    ds_read_b64_tr_b16 v[24:25], v18 offset:36864
    ds_read_b64_tr_b16 v[26:27], v18 offset:37248
    s_add_u32 m0, s49, 100480
    s_add_u32 s48, s48, 57344
    buffer_load_dwordx4 v7, s[20:23], s48 offen lds
    s_waitcnt vmcnt(11)
    s_waitcnt lgkmcnt(6)
    v_mfma_f32_32x32x16_bf16 v[192:207], v[32:35], a[88:91], v[192:207]
    ds_read_b64_tr_b16 v[28:29], v18 offset:36896
    ds_read_b64_tr_b16 v[30:31], v18 offset:37280
    v_mfma_f32_32x32x16_bf16 v[208:223], v[36:39], a[88:91], v[208:223]
    ds_read_b64_tr_b16 v[32:33], v18 offset:38400
    ds_read_b64_tr_b16 v[34:35], v18 offset:38784
    s_waitcnt vmcnt(10)
    s_waitcnt lgkmcnt(6)
    v_mfma_f32_32x32x16_bf16 v[192:207], v[40:43], a[92:95], v[192:207]
    ds_read_b64_tr_b16 v[36:37], v18 offset:38432
    ds_read_b64_tr_b16 v[38:39], v18 offset:38816
    s_add_u32 m0, s49, 102528
    s_add_u32 s48, s48, 57344
    buffer_load_dwordx4 v7, s[20:23], s48 offen lds
    v_mfma_f32_32x32x16_bf16 v[208:223], v[44:47], a[92:95], v[208:223]
    ds_read_b64_tr_b16 v[40:41], v18 offset:39936
    ds_read_b64_tr_b16 v[42:43], v18 offset:40320
    s_waitcnt vmcnt(10)
    s_waitcnt lgkmcnt(6)
    v_mfma_f32_32x32x16_bf16 v[192:207], v[24:27], a[96:99], v[192:207]
    ds_read_b64_tr_b16 v[44:45], v18 offset:39968
    ds_read_b64_tr_b16 v[46:47], v18 offset:40352
    v_mfma_f32_32x32x16_bf16 v[208:223], v[28:31], a[96:99], v[208:223]
    ds_read_b64_tr_b16 v[24:25], v18 offset:41472
    ds_read_b64_tr_b16 v[26:27], v18 offset:41856
    s_add_u32 m0, s49, 104576
    s_add_u32 s48, s48, 57344
    buffer_load_dwordx4 v7, s[20:23], s48 offen lds
    s_waitcnt vmcnt(10)
    s_waitcnt lgkmcnt(6)
    v_mfma_f32_32x32x16_bf16 v[192:207], v[32:35], a[100:103], v[192:207]
    ds_read_b64_tr_b16 v[28:29], v18 offset:41504
    ds_read_b64_tr_b16 v[30:31], v18 offset:41888
    v_mfma_f32_32x32x16_bf16 v[208:223], v[36:39], a[100:103], v[208:223]
    ds_read_b64_tr_b16 v[32:33], v18 offset:43008
    ds_read_b64_tr_b16 v[34:35], v18 offset:43392
    s_waitcnt vmcnt(9)
    s_waitcnt lgkmcnt(6)
    v_mfma_f32_32x32x16_bf16 v[192:207], v[40:43], a[104:107], v[192:207]
    ds_read_b64_tr_b16 v[36:37], v18 offset:43040
    ds_read_b64_tr_b16 v[38:39], v18 offset:43424
    s_add_u32 m0, s49, 106624
    s_add_u32 s48, s48, 57344
    s_cmp_eq_u32 s48, s100
    s_cselect_b32 s36, 1835008, 0
    s_sub_u32 s48, s48, s36
    buffer_load_dwordx4 v7, s[20:23], s48 offen lds
    v_mfma_f32_32x32x16_bf16 v[208:223], v[44:47], a[104:107], v[208:223]
    ds_read_b64_tr_b16 v[40:41], v18 offset:44544
    ds_read_b64_tr_b16 v[42:43], v18 offset:44928
    s_waitcnt vmcnt(9)
    s_waitcnt lgkmcnt(6)
    v_mfma_f32_32x32x16_bf16 v[192:207], v[24:27], a[108:111], v[192:207]
    ds_read_b64_tr_b16 v[44:45], v18 offset:44576
    ds_read_b64_tr_b16 v[46:47], v18 offset:44960
    v_mfma_f32_32x32x16_bf16 v[208:223], v[28:31], a[108:111], v[208:223]
    ds_read_b64_tr_b16 v[24:25], v18 offset:46080
    ds_read_b64_tr_b16 v[26:27], v18 offset:46464
    s_add_u32 m0, s49, 108672
    s_add_u32 s48, s48, 57344
    buffer_load_dwordx4 v7, s[20:23], s48 offen lds
    s_waitcnt vmcnt(9)
    s_waitcnt lgkmcnt(6)
    v_mfma_f32_32x32x16_bf16 v[192:207], v[32:35], a[112:115], v[192:207]
    ds_read_b64_tr_b16 v[28:29], v18 offset:46112
    ds_read_b64_tr_b16 v[30:31], v18 offset:46496
    v_mfma_f32_32x32x16_bf16 v[208:223], v[36:39], a[112:115], v[208:223]
    ds_read_b64_tr_b16 v[32:33], v18 offset:47616
    ds_read_b64_tr_b16 v[34:35], v18 offset:48000
    s_waitcnt vmcnt(8)
    s_waitcnt lgkmcnt(6)
    v_mfma_f32_32x32x16_bf16 v[192:207], v[40:43], a[116:119], v[192:207]
    ds_read_b64_tr_b16 v[36:37], v18 offset:47648
    ds_read_b64_tr_b16 v[38:39], v18 offset:48032
    s_add_u32 m0, s49, 110720
    s_add_u32 s48, s48, 57344
    buffer_load_dwordx4 v7, s[20:23], s48 offen lds
    v_mfma_f32_32x32x16_bf16 v[208:223], v[44:47], a[116:119], v[208:223]
    ds_read_b64_tr_b16 v[40:41], v18 offset:64
    ds_read_b64_tr_b16 v[42:43], v18 offset:448
    s_waitcnt vmcnt(8)
    s_waitcnt lgkmcnt(6)
    v_mfma_f32_32x32x16_bf16 v[192:207], v[24:27], a[120:123], v[192:207]
    ds_read_b64_tr_b16 v[44:45], v18 offset:1600
    ds_read_b64_tr_b16 v[46:47], v18 offset:1984
    v_mfma_f32_32x32x16_bf16 v[208:223], v[28:31], a[120:123], v[208:223]
    ds_read_b64_tr_b16 v[24:25], v18 offset:3136
    ds_read_b64_tr_b16 v[26:27], v18 offset:3520
    s_add_u32 m0, s49, 112768
    s_add_u32 s48, s48, 57344
    buffer_load_dwordx4 v7, s[20:23], s48 offen lds
    s_waitcnt vmcnt(8)
    s_waitcnt lgkmcnt(6)
    v_mfma_f32_32x32x16_bf16 v[192:207], v[32:35], a[124:127], v[192:207]
    ds_read_b64_tr_b16 v[28:29], v18 offset:4672
    ds_read_b64_tr_b16 v[30:31], v18 offset:5056
    v_mfma_f32_32x32x16_bf16 v[208:223], v[36:39], a[124:127], v[208:223]
    ds_read_b64_tr_b16 v[32:33], v18 offset:6208
    ds_read_b64_tr_b16 v[34:35], v18 offset:6592
    s_waitcnt lgkmcnt(6)
    v_mfma_f32_32x32x16_bf16 v[224:239], v[40:43], a[0:3], 0
    ds_read_b64_tr_b16 v[36:37], v18 offset:7744
    ds_read_b64_tr_b16 v[38:39], v18 offset:8128
    s_add_u32 m0, s49, 114816
    s_add_u32 s48, s48, 57344
    s_cmp_eq_u32 s48, s100
    s_cselect_b32 s36, 1835008, 0
    s_sub_u32 s48, s48, s36
    buffer_load_dwordx4 v7, s[20:23], s48 offen lds
    v_mfma_f32_32x32x16_bf16 v[224:239], v[44:47], a[4:7], v[224:239]
    ds_read_b64_tr_b16 v[40:41], v18 offset:9280
    ds_read_b64_tr_b16 v[42:43], v18 offset:9664
    v_mul_f32 v48, v192, v192
    v_mul_f32 v49, v193, v193
    v_mul_f32 v50, v194, v194
    v_mul_f32 v51, v195, v195
    s_waitcnt lgkmcnt(6)
    v_mfma_f32_32x32x16_bf16 v[224:239], v[24:27], a[8:11], v[224:239]
    ds_read_b64_tr_b16 v[44:45], v18 offset:10816
    ds_read_b64_tr_b16 v[46:47], v18 offset:11200
    v_fma_f32 v48, v48, s44, v2
    v_fma_f32 v49, v49, s44, v2
    v_fma_f32 v50, v50, s44, v2
    v_mfma_f32_32x32x16_bf16 v[224:239], v[28:31], a[12:15], v[224:239]
    ds_read_b64_tr_b16 v[24:25], v18 offset:12352
    ds_read_b64_tr_b16 v[26:27], v18 offset:12736
    s_add_u32 m0, s49, 116864
    s_add_u32 s48, s48, 57344
    buffer_load_dwordx4 v7, s[20:23], s48 offen lds
    v_fma_f32 v51, v51, s44, v2
    s_waitcnt lgkmcnt(6)
    v_mfma_f32_32x32x16_bf16 v[224:239], v[32:35], a[16:19], v[224:239]
    ds_read_b64_tr_b16 v[28:29], v18 offset:13888
    ds_read_b64_tr_b16 v[30:31], v18 offset:14272
    v_mul_f32 v48, v48, v192
    v_mul_f32 v49, v49, v193
    v_mul_f32 v50, v50, v194
    v_mfma_f32_32x32x16_bf16 v[224:239], v[36:39], a[20:23], v[224:239]
    ds_read_b64_tr_b16 v[32:33], v18 offset:15424
    ds_read_b64_tr_b16 v[34:35], v18 offset:15808
    v_mul_f32 v51, v51, v195
    v_exp_f32 v48, v48
    v_mul_f32 v192, v192, v200
    s_waitcnt lgkmcnt(6)
    v_mfma_f32_32x32x16_bf16 v[224:239], v[40:43], a[24:27], v[224:239]
    ds_read_b64_tr_b16 v[36:37], v18 offset:16960
    ds_read_b64_tr_b16 v[38:39], v18 offset:17344
    s_add_u32 m0, s49, 118912
    s_add_u32 s48, s48, 57344
    buffer_load_dwordx4 v7, s[20:23], s48 offen lds
    v_mfma_f32_32x32x16_bf16 v[224:239], v[44:47], a[28:31], v[224:239]
    ds_read_b64_tr_b16 v[40:41], v18 offset:18496
    ds_read_b64_tr_b16 v[42:43], v18 offset:18880
    v_exp_f32 v49, v49
    v_mul_f32 v193, v193, v201
    s_waitcnt lgkmcnt(6)
    v_mfma_f32_32x32x16_bf16 v[224:239], v[24:27], a[32:35], v[224:239]
    ds_read_b64_tr_b16 v[44:45], v18 offset:20032
    ds_read_b64_tr_b16 v[46:47], v18 offset:20416
    v_exp_f32 v50, v50
    v_mul_f32 v194, v194, v202
    v_mfma_f32_32x32x16_bf16 v[224:239], v[28:31], a[36:39], v[224:239]
    ds_read_b64_tr_b16 v[24:25], v18 offset:21568
    ds_read_b64_tr_b16 v[26:27], v18 offset:21952
    s_add_u32 m0, s49, 120960
    s_add_u32 s48, s48, 57344
    buffer_load_dwordx4 v7, s[20:23], s48 offen lds
    s_waitcnt lgkmcnt(6)
    v_mfma_f32_32x32x16_bf16 v[224:239], v[32:35], a[40:43], v[224:239]
    ds_read_b64_tr_b16 v[28:29], v18 offset:23104
    ds_read_b64_tr_b16 v[30:31], v18 offset:23488
    v_exp_f32 v51, v51
    v_mul_f32 v195, v195, v203
    v_add_f32 v48, 1.0, v48
    v_mfma_f32_32x32x16_bf16 v[224:239], v[36:39], a[44:47], v[224:239]
    ds_read_b64_tr_b16 v[32:33], v18 offset:24640
    ds_read_b64_tr_b16 v[34:35], v18 offset:25024
    v_add_f32 v49, 1.0, v49
    v_add_f32 v50, 1.0, v50
    s_waitcnt lgkmcnt(6)
    v_mfma_f32_32x32x16_bf16 v[224:239], v[40:43], a[48:51], v[224:239]
    ds_read_b64_tr_b16 v[36:37], v18 offset:26176
    ds_read_b64_tr_b16 v[38:39], v18 offset:26560
    s_add_u32 m0, s49, 123008
    s_add_u32 s48, s48, 57344
    s_cmp_eq_u32 s48, s100
    s_cselect_b32 s36, 1835008, 0
    s_sub_u32 s48, s48, s36
    buffer_load_dwordx4 v7, s[20:23], s48 offen lds
    v_mfma_f32_32x32x16_bf16 v[224:239], v[44:47], a[52:55], v[224:239]
    ds_read_b64_tr_b16 v[40:41], v18 offset:27712
    ds_read_b64_tr_b16 v[42:43], v18 offset:28096
    v_rcp_f32 v48, v48
    v_add_f32 v51, 1.0, v51
    s_waitcnt lgkmcnt(6)
    v_mfma_f32_32x32x16_bf16 v[224:239], v[24:27], a[56:59], v[224:239]
    ds_read_b64_tr_b16 v[44:45], v18 offset:29248
    ds_read_b64_tr_b16 v[46:47], v18 offset:29632
    v_rcp_f32 v49, v49
    v_mul_f32 v192, v192, v48
    v_mfma_f32_32x32x16_bf16 v[224:239], v[28:31], a[60:63], v[224:239]
    ds_read_b64_tr_b16 v[24:25], v18 offset:30784
    ds_read_b64_tr_b16 v[26:27], v18 offset:31168
    s_barrier
    s_add_u32 m0, s49, 125056
    s_add_u32 s48, s48, 57344
    buffer_load_dwordx4 v7, s[20:23], s48 offen lds
    s_waitcnt lgkmcnt(6)
    v_mfma_f32_32x32x16_bf16 v[224:239], v[32:35], a[64:67], v[224:239]
    ds_read_b64_tr_b16 v[28:29], v18 offset:32320
    ds_read_b64_tr_b16 v[30:31], v18 offset:32704
    v_rcp_f32 v50, v50
    v_mul_f32 v193, v193, v49
    v_mfma_f32_32x32x16_bf16 v[224:239], v[36:39], a[68:71], v[224:239]
    ds_read_b64_tr_b16 v[32:33], v18 offset:33856
    ds_read_b64_tr_b16 v[34:35], v18 offset:34240
    v_rcp_f32 v51, v51
    v_mul_f32 v194, v194, v50
    v_mul_f32 v195, v195, v51
    s_waitcnt lgkmcnt(6)
    v_mfma_f32_32x32x16_bf16 v[224:239], v[40:43], a[72:75], v[224:239]
    ds_read_b64_tr_b16 v[36:37], v18 offset:35392
    ds_read_b64_tr_b16 v[38:39], v18 offset:35776
    s_add_u32 m0, s49, 127104
    s_add_u32 s48, s48, 57344
    buffer_load_dwordx4 v7, s[20:23], s48 offen lds
    v_mfma_f32_32x32x16_bf16 v[224:239], v[44:47], a[76:79], v[224:239]
    ds_read_b64_tr_b16 v[40:41], v18 offset:36928
    ds_read_b64_tr_b16 v[42:43], v18 offset:37312
    v_cvt_pk_bf16_f32 v64, v192, v193
    v_cvt_pk_bf16_f32 v65, v194, v195
    v_mul_f32 v52, v196, v196
    v_mul_f32 v53, v197, v197
    s_waitcnt lgkmcnt(6)
    v_mfma_f32_32x32x16_bf16 v[224:239], v[24:27], a[80:83], v[224:239]
    ds_read_b64_tr_b16 v[44:45], v18 offset:38464
    ds_read_b64_tr_b16 v[46:47], v18 offset:38848
    v_mul_f32 v54, v198, v198
    v_mul_f32 v55, v199, v199
    v_fma_f32 v52, v52, s44, v2
    v_mfma_f32_32x32x16_bf16 v[224:239], v[28:31], a[84:87], v[224:239]
    ds_read_b64_tr_b16 v[24:25], v18 offset:40000
    ds_read_b64_tr_b16 v[26:27], v18 offset:40384
    s_add_u32 m0, s43, 0
    s_add_u32 s48, s48, 57344
    buffer_load_dwordx4 v7, s[20:23], s48 offen lds
    v_fma_f32 v53, v53, s44, v2
    s_waitcnt lgkmcnt(6)
    v_mfma_f32_32x32x16_bf16 v[224:239], v[32:35], a[88:91], v[224:239]
    ds_read_b64_tr_b16 v[28:29], v18 offset:41536
    ds_read_b64_tr_b16 v[30:31], v18 offset:41920
    v_fma_f32 v54, v54, s44, v2
    v_fma_f32 v55, v55, s44, v2
    v_mul_f32 v52, v52, v196
    v_mfma_f32_32x32x16_bf16 v[224:239], v[36:39], a[92:95], v[224:239]
    ds_read_b64_tr_b16 v[32:33], v18 offset:43072
    ds_read_b64_tr_b16 v[34:35], v18 offset:43456
    v_mul_f32 v53, v53, v197
    v_mul_f32 v54, v54, v198
    v_mul_f32 v55, v55, v199
    s_waitcnt lgkmcnt(6)
    v_mfma_f32_32x32x16_bf16 v[224:239], v[40:43], a[96:99], v[224:239]
    ds_read_b64_tr_b16 v[36:37], v18 offset:44608
    ds_read_b64_tr_b16 v[38:39], v18 offset:44992
    s_add_u32 m0, s43, 2048
    s_add_u32 s48, s48, 57344
    s_cmp_eq_u32 s48, s100
    s_cselect_b32 s36, 1835008, 0
    s_sub_u32 s48, s48, s36
    buffer_load_dwordx4 v7, s[20:23], s48 offen lds
    v_mfma_f32_32x32x16_bf16 v[224:239], v[44:47], a[100:103], v[224:239]
    ds_read_b64_tr_b16 v[40:41], v18 offset:46144
    ds_read_b64_tr_b16 v[42:43], v18 offset:46528
    s_waitcnt vmcnt(10)
    s_barrier
    v_exp_f32 v52, v52
    v_mul_f32 v196, v196, v204
    s_waitcnt lgkmcnt(6)
    v_mfma_f32_32x32x16_bf16 v[224:239], v[24:27], a[104:107], v[224:239]
    ds_read_b64_tr_b16 v[44:45], v18 offset:47680
    ds_read_b64_tr_b16 v[46:47], v18 offset:48064
    v_exp_f32 v53, v53
    v_mul_f32 v197, v197, v205
    v_mfma_f32_32x32x16_bf16 v[224:239], v[28:31], a[108:111], v[224:239]
    ds_read_b64_tr_b16 v[24:25], v246 offset:0
    ds_read_b64_tr_b16 v[26:27], v246 offset:512
    s_add_u32 m0, s43, 4096
    s_add_u32 s48, s48, 57344
    buffer_load_dwordx4 v7, s[20:23], s48 offen lds
    s_waitcnt lgkmcnt(6)
    v_mfma_f32_32x32x16_bf16 v[224:239], v[32:35], a[112:115], v[224:239]
    ds_read_b64_tr_b16 v[28:29], v247 offset:0
    ds_read_b64_tr_b16 v[30:31], v247 offset:512
    v_exp_f32 v54, v54
    v_mul_f32 v198, v198, v206
    v_mfma_f32_32x32x16_bf16 v[224:239], v[36:39], a[116:119], v[224:239]
    ds_read_b64_tr_b16 v[32:33], v248 offset:0
    ds_read_b64_tr_b16 v[34:35], v248 offset:512
    v_exp_f32 v55, v55
    v_mul_f32 v199, v199, v207
    v_add_f32 v52, 1.0, v52
    s_waitcnt lgkmcnt(6)
    v_mfma_f32_32x32x16_bf16 v[224:239], v[40:43], a[120:123], v[224:239]
    ds_read_b64_tr_b16 v[36:37], v249 offset:0
    ds_read_b64_tr_b16 v[38:39], v249 offset:512
    s_add_u32 m0, s43, 6144
    s_add_u32 s48, s48, 57344
    buffer_load_dwordx4 v7, s[20:23], s48 offen lds
    v_mfma_f32_32x32x16_bf16 v[224:239], v[44:47], a[124:127], v[224:239]
    ds_read_b64_tr_b16 v[40:41], v246 offset:2048
    ds_read_b64_tr_b16 v[42:43], v246 offset:2560
    v_add_f32 v53, 1.0, v53
    v_add_f32 v54, 1.0, v54
    v_rcp_f32 v52, v52
    s_waitcnt lgkmcnt(6)
    v_mfma_f32_32x32x16_bf16 v[128:143], v[24:27], a[0:3], 0
    ds_read_b64_tr_b16 v[44:45], v247 offset:2048
    ds_read_b64_tr_b16 v[46:47], v247 offset:2560
    v_add_f32 v55, 1.0, v55
    v_rcp_f32 v53, v53
    v_mfma_f32_32x32x16_bf16 v[144:159], v[28:31], a[0:3], 0
    ds_read_b64_tr_b16 v[24:25], v248 offset:2048
    ds_read_b64_tr_b16 v[26:27], v248 offset:2560
    s_add_u32 m0, s43, 8192
    s_add_u32 s48, s48, 57344
    buffer_load_dwordx4 v7, s[20:23], s48 offen lds
    v_mul_f32 v196, v196, v52
    s_waitcnt lgkmcnt(6)
    v_mfma_f32_32x32x16_bf16 v[160:175], v[32:35], a[0:3], 0
    ds_read_b64_tr_b16 v[28:29], v249 offset:2048
    ds_read_b64_tr_b16 v[30:31], v249 offset:2560
    v_rcp_f32 v54, v54
    v_mul_f32 v197, v197, v53
    v_mfma_f32_32x32x16_bf16 v[176:191], v[36:39], a[0:3], 0
    ds_read_b64_tr_b16 v[32:33], v246 offset:4096
    ds_read_b64_tr_b16 v[34:35], v246 offset:4608
    v_rcp_f32 v55, v55
    v_mul_f32 v198, v198, v54
    v_mul_f32 v199, v199, v55
    s_waitcnt lgkmcnt(6)
    v_mfma_f32_32x32x16_bf16 v[128:143], v[40:43], a[4:7], v[128:143]
    ds_read_b64_tr_b16 v[36:37], v247 offset:4096
    ds_read_b64_tr_b16 v[38:39], v247 offset:4608
    s_add_u32 m0, s43, 10240
    s_add_u32 s48, s48, 57344
    s_cmp_eq_u32 s48, s100
    s_cselect_b32 s36, 1835008, 0
    s_sub_u32 s48, s48, s36
    buffer_load_dwordx4 v7, s[20:23], s48 offen lds
    v_mfma_f32_32x32x16_bf16 v[144:159], v[44:47], a[4:7], v[144:159]
    ds_read_b64_tr_b16 v[40:41], v248 offset:4096
    ds_read_b64_tr_b16 v[42:43], v248 offset:4608
    v_cvt_pk_bf16_f32 v66, v196, v197
    v_cvt_pk_bf16_f32 v67, v198, v199
    buffer_store_dwordx4 v[64:67], v15, s[16:19], s46 offen offset:0 sc1
    v_mul_f32 v56, v208, v208
    v_mul_f32 v57, v209, v209
    s_waitcnt lgkmcnt(6)
    v_mfma_f32_32x32x16_bf16 v[160:175], v[24:27], a[4:7], v[160:175]
    ds_read_b64_tr_b16 v[44:45], v249 offset:4096
    ds_read_b64_tr_b16 v[46:47], v249 offset:4608
    v_mul_f32 v58, v210, v210
    v_mul_f32 v59, v211, v211
    v_fma_f32 v56, v56, s44, v2
    v_mfma_f32_32x32x16_bf16 v[176:191], v[28:31], a[4:7], v[176:191]
    ds_read_b64_tr_b16 v[24:25], v246 offset:6144
    ds_read_b64_tr_b16 v[26:27], v246 offset:6656
    s_add_u32 m0, s43, 12288
    s_add_u32 s48, s48, 57344
    buffer_load_dwordx4 v7, s[20:23], s48 offen lds
    v_fma_f32 v57, v57, s44, v2
    s_waitcnt lgkmcnt(6)
    v_mfma_f32_32x32x16_bf16 v[128:143], v[32:35], a[8:11], v[128:143]
    ds_read_b64_tr_b16 v[28:29], v247 offset:6144
    ds_read_b64_tr_b16 v[30:31], v247 offset:6656
    v_fma_f32 v58, v58, s44, v2
    v_fma_f32 v59, v59, s44, v2
    v_mul_f32 v56, v56, v208
    v_mfma_f32_32x32x16_bf16 v[144:159], v[36:39], a[8:11], v[144:159]
    ds_read_b64_tr_b16 v[32:33], v248 offset:6144
    ds_read_b64_tr_b16 v[34:35], v248 offset:6656
    v_mul_f32 v57, v57, v209
    v_mul_f32 v58, v58, v210
    v_mul_f32 v59, v59, v211
    s_waitcnt lgkmcnt(6)
    v_mfma_f32_32x32x16_bf16 v[160:175], v[40:43], a[8:11], v[160:175]
    ds_read_b64_tr_b16 v[36:37], v249 offset:6144
    ds_read_b64_tr_b16 v[38:39], v249 offset:6656
    s_add_u32 m0, s43, 14336
    s_add_u32 s48, s48, 57344
    buffer_load_dwordx4 v7, s[20:23], s48 offen lds
    v_mfma_f32_32x32x16_bf16 v[176:191], v[44:47], a[8:11], v[176:191]
    ds_read_b64_tr_b16 v[40:41], v246 offset:8192
    ds_read_b64_tr_b16 v[42:43], v246 offset:8704
    v_exp_f32 v56, v56
    v_mul_f32 v208, v208, v216
    s_waitcnt lgkmcnt(6)
    v_mfma_f32_32x32x16_bf16 v[128:143], v[24:27], a[12:15], v[128:143]
    ds_read_b64_tr_b16 v[44:45], v247 offset:8192
    ds_read_b64_tr_b16 v[46:47], v247 offset:8704
    v_exp_f32 v57, v57
    v_mul_f32 v209, v209, v217
    v_mfma_f32_32x32x16_bf16 v[144:159], v[28:31], a[12:15], v[144:159]
    ds_read_b64_tr_b16 v[24:25], v248 offset:8192
    ds_read_b64_tr_b16 v[26:27], v248 offset:8704
    s_add_u32 m0, s43, 16384
    s_add_u32 s48, s48, 57344
    buffer_load_dwordx4 v7, s[20:23], s48 offen lds
    s_waitcnt lgkmcnt(6)
    v_mfma_f32_32x32x16_bf16 v[160:175], v[32:35], a[12:15], v[160:175]
    ds_read_b64_tr_b16 v[28:29], v249 offset:8192
    ds_read_b64_tr_b16 v[30:31], v249 offset:8704
    v_exp_f32 v58, v58
    v_mul_f32 v210, v210, v218
    v_mfma_f32_32x32x16_bf16 v[176:191], v[36:39], a[12:15], v[176:191]
    ds_read_b64_tr_b16 v[32:33], v246 offset:10240
    ds_read_b64_tr_b16 v[34:35], v246 offset:10752
    v_exp_f32 v59, v59
    v_mul_f32 v211, v211, v219
    v_add_f32 v56, 1.0, v56
    s_waitcnt lgkmcnt(6)
    v_mfma_f32_32x32x16_bf16 v[128:143], v[40:43], a[16:19], v[128:143]
    ds_read_b64_tr_b16 v[36:37], v247 offset:10240
    ds_read_b64_tr_b16 v[38:39], v247 offset:10752
    s_add_u32 m0, s43, 18432
    s_add_u32 s48, s48, 57344
    s_cmp_eq_u32 s48, s100
    s_cselect_b32 s36, 1835008, 0
    s_sub_u32 s48, s48, s36
    buffer_load_dwordx4 v7, s[20:23], s48 offen lds
    v_mfma_f32_32x32x16_bf16 v[144:159], v[44:47], a[16:19], v[144:159]
    ds_read_b64_tr_b16 v[40:41], v248 offset:10240
    ds_read_b64_tr_b16 v[42:43], v248 offset:10752
    v_add_f32 v57, 1.0, v57
    v_add_f32 v58, 1.0, v58
    v_rcp_f32 v56, v56
    s_waitcnt lgkmcnt(6)
    v_mfma_f32_32x32x16_bf16 v[160:175], v[24:27], a[16:19], v[160:175]
    ds_read_b64_tr_b16 v[44:45], v249 offset:10240
    ds_read_b64_tr_b16 v[46:47], v249 offset:10752
    v_add_f32 v59, 1.0, v59
    v_rcp_f32 v57, v57
    v_mfma_f32_32x32x16_bf16 v[176:191], v[28:31], a[16:19], v[176:191]
    ds_read_b64_tr_b16 v[24:25], v246 offset:12288
    ds_read_b64_tr_b16 v[26:27], v246 offset:12800
    s_waitcnt vmcnt(11)
    s_barrier
    s_add_u32 m0, s43, 20480
    s_add_u32 s48, s48, 57344
    buffer_load_dwordx4 v7, s[20:23], s48 offen lds
    s_waitcnt lgkmcnt(6)
    v_mfma_f32_32x32x16_bf16 v[128:143], v[32:35], a[20:23], v[128:143]
    ds_read_b64_tr_b16 v[28:29], v247 offset:12288
    ds_read_b64_tr_b16 v[30:31], v247 offset:12800
    s_add_u32 m0, s26, 40960
    s_nop 0
    buffer_load_dwordx4 v8, s[8:11], s37 offen sc1 lds
    v_mfma_f32_32x32x16_bf16 v[144:159], v[36:39], a[20:23], v[144:159]
    ds_read_b64_tr_b16 v[32:33], v248 offset:12288
    ds_read_b64_tr_b16 v[34:35], v248 offset:12800
    buffer_load_dwordx4 v9, s[8:11], s37 offen offset:1024 sc1 lds
    v_mul_f32 v208, v208, v56
    v_rcp_f32 v58, v58
    s_waitcnt lgkmcnt(6)
    v_mfma_f32_32x32x16_bf16 v[160:175], v[40:43], a[20:23], v[160:175]
    ds_read_b64_tr_b16 v[36:37], v249 offset:12288
    ds_read_b64_tr_b16 v[38:39], v249 offset:12800
    v_mul_f32 v209, v209, v57
    v_rcp_f32 v59, v59
    v_mfma_f32_32x32x16_bf16 v[176:191], v[44:47], a[20:23], v[176:191]
    ds_read_b64_tr_b16 v[40:41], v246 offset:14336
    ds_read_b64_tr_b16 v[42:43], v246 offset:14848
    s_add_u32 m0, s43, 22528
    s_add_u32 s48, s48, 57344
    buffer_load_dwordx4 v7, s[20:23], s48 offen lds
    v_mul_f32 v210, v210, v58
    s_waitcnt lgkmcnt(6)
    v_mfma_f32_32x32x16_bf16 v[128:143], v[24:27], a[24:27], v[128:143]
    ds_read_b64_tr_b16 v[44:45], v247 offset:14336
    ds_read_b64_tr_b16 v[46:47], v247 offset:14848
    s_add_u32 m0, s26, 90112
    s_add_u32 s37, s37, 2048
    buffer_load_dwordx4 v8, s[8:11], s37 offen sc1 lds
    v_mfma_f32_32x32x16_bf16 v[144:159], v[28:31], a[24:27], v[144:159]
    ds_read_b64_tr_b16 v[24:25], v248 offset:14336
    ds_read_b64_tr_b16 v[26:27], v248 offset:14848
    v_mul_f32 v211, v211, v59
    v_cvt_pk_bf16_f32 v68, v208, v209
    v_cvt_pk_bf16_f32 v69, v210, v211
    v_mul_f32 v60, v212, v212
    s_waitcnt lgkmcnt(6)
    v_mfma_f32_32x32x16_bf16 v[160:175], v[32:35], a[24:27], v[160:175]
    ds_read_b64_tr_b16 v[28:29], v249 offset:14336
    ds_read_b64_tr_b16 v[30:31], v249 offset:14848
    buffer_load_dwordx4 v9, s[8:11], s37 offen offset:1024 sc1 lds
    v_mul_f32 v61, v213, v213
    v_mul_f32 v62, v214, v214
    v_mfma_f32_32x32x16_bf16 v[176:191], v[36:39], a[24:27], v[176:191]
    ds_read_b64_tr_b16 v[32:33], v246 offset:16384
    ds_read_b64_tr_b16 v[34:35], v246 offset:16896
    s_add_u32 m0, s43, 24576
    s_add_u32 s48, s48, 57344
    buffer_load_dwordx4 v7, s[20:23], s48 offen lds
    v_mul_f32 v63, v215, v215
    s_waitcnt lgkmcnt(6)
    v_mfma_f32_32x32x16_bf16 v[128:143], v[40:43], a[28:31], v[128:143]
    ds_read_b64_tr_b16 v[36:37], v247 offset:16384
    ds_read_b64_tr_b16 v[38:39], v247 offset:16896
    v_fma_f32 v60, v60, s44, v2
    v_fma_f32 v61, v61, s44, v2
    v_fma_f32 v62, v62, s44, v2
    v_mfma_f32_32x32x16_bf16 v[144:159], v[44:47], a[28:31], v[144:159]
    ds_read_b64_tr_b16 v[40:41], v248 offset:16384
    ds_read_b64_tr_b16 v[42:43], v248 offset:16896
    v_fma_f32 v63, v63, s44, v2
    v_mul_f32 v60, v60, v212
    v_mul_f32 v61, v61, v213
    v_mul_f32 v62, v62, v214
    s_waitcnt lgkmcnt(6)
    v_mfma_f32_32x32x16_bf16 v[160:175], v[24:27], a[28:31], v[160:175]
    ds_read_b64_tr_b16 v[44:45], v249 offset:16384
    ds_read_b64_tr_b16 v[46:47], v249 offset:16896
    s_add_u32 m0, s43, 26624
    s_add_u32 s48, s48, 57344
    s_cmp_eq_u32 s48, s100
    s_cselect_b32 s36, 1835008, 0
    s_sub_u32 s48, s48, s36
    buffer_load_dwordx4 v7, s[20:23], s48 offen lds
    v_mfma_f32_32x32x16_bf16 v[176:191], v[28:31], a[28:31], v[176:191]
    ds_read_b64_tr_b16 v[24:25], v246 offset:18432
    ds_read_b64_tr_b16 v[26:27], v246 offset:18944
    v_mul_f32 v63, v63, v215
    v_exp_f32 v60, v60
    v_mul_f32 v212, v212, v220
    s_waitcnt lgkmcnt(6)
    v_mfma_f32_32x32x16_bf16 v[128:143], v[32:35], a[32:35], v[128:143]
    ds_read_b64_tr_b16 v[28:29], v247 offset:18432
    ds_read_b64_tr_b16 v[30:31], v247 offset:18944
    v_exp_f32 v61, v61
    v_mul_f32 v213, v213, v221
    v_mfma_f32_32x32x16_bf16 v[144:159], v[36:39], a[32:35], v[144:159]
    ds_read_b64_tr_b16 v[32:33], v248 offset:18432
    ds_read_b64_tr_b16 v[34:35], v248 offset:18944
    s_add_u32 m0, s43, 28672
    s_add_u32 s48, s48, 57344
    buffer_load_dwordx4 v7, s[20:23], s48 offen lds
    s_waitcnt lgkmcnt(6)
    v_mfma_f32_32x32x16_bf16 v[160:175], v[40:43], a[32:35], v[160:175]
    ds_read_b64_tr_b16 v[36:37], v249 offset:18432
    ds_read_b64_tr_b16 v[38:39], v249 offset:18944
    v_exp_f32 v62, v62
    v_mul_f32 v214, v214, v222
    v_mfma_f32_32x32x16_bf16 v[176:191], v[44:47], a[32:35], v[176:191]
    ds_read_b64_tr_b16 v[40:41], v246 offset:20480
    ds_read_b64_tr_b16 v[42:43], v246 offset:20992
    v_exp_f32 v63, v63
    v_mul_f32 v215, v215, v223
    v_add_f32 v60, 1.0, v60
    s_waitcnt lgkmcnt(6)
    v_mfma_f32_32x32x16_bf16 v[128:143], v[24:27], a[36:39], v[128:143]
    ds_read_b64_tr_b16 v[44:45], v247 offset:20480
    ds_read_b64_tr_b16 v[46:47], v247 offset:20992
    s_add_u32 m0, s43, 30720
    s_add_u32 s48, s48, 57344
    buffer_load_dwordx4 v7, s[20:23], s48 offen lds
    v_mfma_f32_32x32x16_bf16 v[144:159], v[28:31], a[36:39], v[144:159]
    ds_read_b64_tr_b16 v[24:25], v248 offset:20480
    ds_read_b64_tr_b16 v[26:27], v248 offset:20992
    v_add_f32 v61, 1.0, v61
    v_add_f32 v62, 1.0, v62
    v_rcp_f32 v60, v60
    s_waitcnt lgkmcnt(6)
    v_mfma_f32_32x32x16_bf16 v[160:175], v[32:35], a[36:39], v[160:175]
    ds_read_b64_tr_b16 v[28:29], v249 offset:20480
    ds_read_b64_tr_b16 v[30:31], v249 offset:20992
    v_add_f32 v63, 1.0, v63
    v_rcp_f32 v61, v61
    v_mfma_f32_32x32x16_bf16 v[176:191], v[36:39], a[36:39], v[176:191]
    ds_read_b64_tr_b16 v[32:33], v246 offset:22528
    ds_read_b64_tr_b16 v[34:35], v246 offset:23040
    s_add_u32 m0, s43, 32768
    s_add_u32 s48, s48, 57344
    buffer_load_dwordx4 v7, s[20:23], s48 offen lds
    v_mul_f32 v212, v212, v60
    s_waitcnt lgkmcnt(6)
    v_mfma_f32_32x32x16_bf16 v[128:143], v[40:43], a[40:43], v[128:143]
    ds_read_b64_tr_b16 v[36:37], v247 offset:22528
    ds_read_b64_tr_b16 v[38:39], v247 offset:23040
    v_rcp_f32 v62, v62
    v_mul_f32 v213, v213, v61
    v_mfma_f32_32x32x16_bf16 v[144:159], v[44:47], a[40:43], v[144:159]
    ds_read_b64_tr_b16 v[40:41], v248 offset:22528
    ds_read_b64_tr_b16 v[42:43], v248 offset:23040
    v_rcp_f32 v63, v63
    v_mul_f32 v214, v214, v62
    v_mul_f32 v215, v215, v63
    s_waitcnt lgkmcnt(6)
    v_mfma_f32_32x32x16_bf16 v[160:175], v[24:27], a[40:43], v[160:175]
    ds_read_b64_tr_b16 v[44:45], v249 offset:22528
    ds_read_b64_tr_b16 v[46:47], v249 offset:23040
    v_cvt_pk_bf16_f32 v70, v212, v213
    v_cvt_pk_bf16_f32 v71, v214, v215
    buffer_store_dwordx4 v[68:71], v15, s[16:19], s46 offen offset:1024 sc1
    v_mul_f32 v48, v224, v224
    v_mfma_f32_32x32x16_bf16 v[176:191], v[28:31], a[40:43], v[176:191]
    ds_read_b64_tr_b16 v[24:25], v246 offset:24576
    ds_read_b64_tr_b16 v[26:27], v246 offset:25088
    v_mul_f32 v49, v225, v225
    v_mul_f32 v50, v226, v226
    v_mul_f32 v51, v227, v227
    v_fma_f32 v48, v48, s44, v2
    s_waitcnt lgkmcnt(6)
    v_mfma_f32_32x32x16_bf16 v[128:143], v[32:35], a[44:47], v[128:143]
    ds_read_b64_tr_b16 v[28:29], v247 offset:24576
    ds_read_b64_tr_b16 v[30:31], v247 offset:25088
    v_fma_f32 v49, v49, s44, v2
    v_fma_f32 v50, v50, s44, v2
    v_fma_f32 v51, v51, s44, v2
    v_mfma_f32_32x32x16_bf16 v[144:159], v[36:39], a[44:47], v[144:159]
    ds_read_b64_tr_b16 v[32:33], v248 offset:24576
    ds_read_b64_tr_b16 v[34:35], v248 offset:25088
    v_mul_f32 v48, v48, v224
    v_mul_f32 v49, v49, v225
    v_mul_f32 v50, v50, v226
    v_mul_f32 v51, v51, v227
    s_waitcnt lgkmcnt(6)
    v_mfma_f32_32x32x16_bf16 v[160:175], v[40:43], a[44:47], v[160:175]
    ds_read_b64_tr_b16 v[36:37], v249 offset:24576
    ds_read_b64_tr_b16 v[38:39], v249 offset:25088
    v_exp_f32 v48, v48
    v_mul_f32 v224, v224, v232
    v_mfma_f32_32x32x16_bf16 v[176:191], v[44:47], a[44:47], v[176:191]
    ds_read_b64_tr_b16 v[40:41], v246 offset:26624
    ds_read_b64_tr_b16 v[42:43], v246 offset:27136
    v_exp_f32 v49, v49
    v_mul_f32 v225, v225, v233
    s_waitcnt lgkmcnt(6)
    v_mfma_f32_32x32x16_bf16 v[128:143], v[24:27], a[48:51], v[128:143]
    ds_read_b64_tr_b16 v[44:45], v247 offset:26624
    ds_read_b64_tr_b16 v[46:47], v247 offset:27136
    v_exp_f32 v50, v50
    v_mul_f32 v226, v226, v234
    v_mfma_f32_32x32x16_bf16 v[144:159], v[28:31], a[48:51], v[144:159]
    ds_read_b64_tr_b16 v[24:25], v248 offset:26624
    ds_read_b64_tr_b16 v[26:27], v248 offset:27136
    v_exp_f32 v51, v51
    v_mul_f32 v227, v227, v235
    v_add_f32 v48, 1.0, v48
    s_waitcnt lgkmcnt(6)
    v_mfma_f32_32x32x16_bf16 v[160:175], v[32:35], a[48:51], v[160:175]
    ds_read_b64_tr_b16 v[28:29], v249 offset:26624
    ds_read_b64_tr_b16 v[30:31], v249 offset:27136
    v_add_f32 v49, 1.0, v49
    v_add_f32 v50, 1.0, v50
    v_mfma_f32_32x32x16_bf16 v[176:191], v[36:39], a[48:51], v[176:191]
    ds_read_b64_tr_b16 v[32:33], v246 offset:28672
    ds_read_b64_tr_b16 v[34:35], v246 offset:29184
    s_waitcnt vmcnt(14)
    s_barrier
    s_add_u32 m0, s26, 98304
    s_add_u32 s37, s37, 2048
    buffer_load_dwordx4 v8, s[8:11], s37 offen sc1 lds
    s_waitcnt lgkmcnt(6)
    v_mfma_f32_32x32x16_bf16 v[128:143], v[40:43], a[52:55], v[128:143]
    ds_read_b64_tr_b16 v[36:37], v247 offset:28672
    ds_read_b64_tr_b16 v[38:39], v247 offset:29184
    buffer_load_dwordx4 v9, s[8:11], s37 offen offset:1024 sc1 lds
    v_rcp_f32 v48, v48
    v_mfma_f32_32x32x16_bf16 v[144:159], v[44:47], a[52:55], v[144:159]
    ds_read_b64_tr_b16 v[40:41], v248 offset:28672
    ds_read_b64_tr_b16 v[42:43], v248 offset:29184
    s_add_u32 m0, s26, 106496
    s_add_u32 s37, s37, 2048
    buffer_load_dwordx4 v8, s[8:11], s37 offen sc1 lds
    v_add_f32 v51, 1.0, v51
    s_waitcnt lgkmcnt(6)
    v_mfma_f32_32x32x16_bf16 v[160:175], v[24:27], a[52:55], v[160:175]
    ds_read_b64_tr_b16 v[44:45], v249 offset:28672
    ds_read_b64_tr_b16 v[46:47], v249 offset:29184
    v_rcp_f32 v49, v49
    v_mul_f32 v224, v224, v48
    v_mfma_f32_32x32x16_bf16 v[176:191], v[28:31], a[52:55], v[176:191]
    ds_read_b64_tr_b16 v[24:25], v120 offset:0
    ds_read_b64_tr_b16 v[26:27], v120 offset:512
    buffer_load_dwordx4 v9, s[8:11], s37 offen offset:1024 sc1 lds
    v_rcp_f32 v50, v50
    v_mul_f32 v225, v225, v49
    s_waitcnt lgkmcnt(6)
    v_mfma_f32_32x32x16_bf16 v[128:143], v[32:35], a[56:59], v[128:143]
    ds_read_b64_tr_b16 v[28:29], v121 offset:0
    ds_read_b64_tr_b16 v[30:31], v121 offset:512
    s_add_u32 m0, s26, 114688
    s_add_u32 s37, s37, 2048
    buffer_load_dwordx4 v8, s[8:11], s37 offen sc1 lds
    v_mfma_f32_32x32x16_bf16 v[144:159], v[36:39], a[56:59], v[144:159]
    ds_read_b64_tr_b16 v[32:33], v122 offset:0
    ds_read_b64_tr_b16 v[34:35], v122 offset:512
    v_rcp_f32 v51, v51
    v_mul_f32 v226, v226, v50
    v_mul_f32 v227, v227, v51
    s_waitcnt lgkmcnt(6)
    v_mfma_f32_32x32x16_bf16 v[160:175], v[40:43], a[56:59], v[160:175]
    ds_read_b64_tr_b16 v[36:37], v123 offset:0
    ds_read_b64_tr_b16 v[38:39], v123 offset:512
    buffer_load_dwordx4 v9, s[8:11], s37 offen offset:1024 sc1 lds
    v_cvt_pk_bf16_f32 v112, v224, v225
    v_cvt_pk_bf16_f32 v113, v226, v227
    v_mfma_f32_32x32x16_bf16 v[176:191], v[44:47], a[56:59], v[176:191]
    ds_read_b64_tr_b16 v[40:41], v120 offset:2048
    ds_read_b64_tr_b16 v[42:43], v120 offset:2560
    s_add_u32 m0, s26, 131072
    s_add_u32 s37, s37, 2048
    buffer_load_dwordx4 v8, s[8:11], s37 offen sc1 lds
    v_mul_f32 v52, v228, v228
    s_waitcnt lgkmcnt(6)
    v_mfma_f32_32x32x16_bf16 v[128:143], v[24:27], a[60:63], v[128:143]
    ds_read_b64_tr_b16 v[44:45], v121 offset:2048
    ds_read_b64_tr_b16 v[46:47], v121 offset:2560
    v_mul_f32 v53, v229, v229
    v_mul_f32 v54, v230, v230
    v_mul_f32 v55, v231, v231
    v_mfma_f32_32x32x16_bf16 v[144:159], v[28:31], a[60:63], v[144:159]
    ds_read_b64_tr_b16 v[24:25], v122 offset:2048
    ds_read_b64_tr_b16 v[26:27], v122 offset:2560
    buffer_load_dwordx4 v9, s[8:11], s37 offen offset:1024 sc1 lds
    v_fma_f32 v52, v52, s44, v2
    v_fma_f32 v53, v53, s44, v2
    v_fma_f32 v54, v54, s44, v2
    s_waitcnt lgkmcnt(6)
    v_mfma_f32_32x32x16_bf16 v[160:175], v[32:35], a[60:63], v[160:175]
    ds_read_b64_tr_b16 v[28:29], v123 offset:2048
    ds_read_b64_tr_b16 v[30:31], v123 offset:2560
    s_add_u32 m0, s26, 139264
    s_add_u32 s37, s37, 2048
    buffer_load_dwordx4 v8, s[8:11], s37 offen sc1 lds
    v_mfma_f32_32x32x16_bf16 v[176:191], v[36:39], a[60:63], v[176:191]
    ds_read_b64_tr_b16 v[32:33], v120 offset:4096
    ds_read_b64_tr_b16 v[34:35], v120 offset:4608
    v_fma_f32 v55, v55, s44, v2
    v_mul_f32 v52, v52, v228
    v_mul_f32 v53, v53, v229
    v_mul_f32 v54, v54, v230
    s_waitcnt lgkmcnt(6)
    v_mfma_f32_32x32x16_bf16 v[128:143], v[40:43], a[64:67], v[128:143]
    ds_read_b64_tr_b16 v[36:37], v121 offset:4096
    ds_read_b64_tr_b16 v[38:39], v121 offset:4608
    buffer_load_dwordx4 v9, s[8:11], s37 offen offset:1024 sc1 lds
    v_mul_f32 v55, v55, v231
    v_mfma_f32_32x32x16_bf16 v[144:159], v[44:47], a[64:67], v[144:159]
    ds_read_b64_tr_b16 v[40:41], v122 offset:4096
    ds_read_b64_tr_b16 v[42:43], v122 offset:4608
    s_add_u32 m0, s26, 147456
    s_add_u32 s37, s37, 2048
    buffer_load_dwordx4 v8, s[8:11], s37 offen sc1 lds
    s_waitcnt vmcnt(20)
    ds_read_b64_tr_b16 v[72:73], v240 offset:40960
    s_waitcnt lgkmcnt(7)
    v_mfma_f32_32x32x16_bf16 v[160:175], v[24:27], a[64:67], v[160:175]
    ds_read_b64_tr_b16 v[44:45], v123 offset:4096
    ds_read_b64_tr_b16 v[46:47], v123 offset:4608
    v_exp_f32 v52, v52
    v_mul_f32 v228, v228, v236
    v_mfma_f32_32x32x16_bf16 v[176:191], v[28:31], a[64:67], v[176:191]
    ds_read_b64_tr_b16 v[24:25], v120 offset:6144
    ds_read_b64_tr_b16 v[26:27], v120 offset:6656
    buffer_load_dwordx4 v9, s[8:11], s37 offen offset:1024 sc1 lds
    ds_read_b64_tr_b16 v[74:75], v240 offset:41984
    v_exp_f32 v53, v53
    s_waitcnt lgkmcnt(8)
    v_mfma_f32_32x32x16_bf16 v[128:143], v[32:35], a[68:71], v[128:143]
    ds_read_b64_tr_b16 v[28:29], v121 offset:6144
    ds_read_b64_tr_b16 v[30:31], v121 offset:6656
    v_mul_f32 v229, v229, v237
    v_exp_f32 v54, v54
    v_mfma_f32_32x32x16_bf16 v[144:159], v[36:39], a[68:71], v[144:159]
    ds_read_b64_tr_b16 v[32:33], v122 offset:6144
    ds_read_b64_tr_b16 v[34:35], v122 offset:6656
    ds_read_b64_tr_b16 v[76:77], v241 offset:40960
    v_mul_f32 v230, v230, v238
    v_exp_f32 v55, v55
    s_waitcnt lgkmcnt(8)
    v_mfma_f32_32x32x16_bf16 v[160:175], v[40:43], a[68:71], v[160:175]
    ds_read_b64_tr_b16 v[36:37], v123 offset:6144
    ds_read_b64_tr_b16 v[38:39], v123 offset:6656
    v_mul_f32 v231, v231, v239
    v_add_f32 v52, 1.0, v52
    v_add_f32 v53, 1.0, v53
    v_mfma_f32_32x32x16_bf16 v[176:191], v[44:47], a[68:71], v[176:191]
    ds_read_b64_tr_b16 v[40:41], v120 offset:8192
    ds_read_b64_tr_b16 v[42:43], v120 offset:8704
    ds_read_b64_tr_b16 v[78:79], v241 offset:41984
    v_add_f32 v54, 1.0, v54
    v_rcp_f32 v52, v52
    s_waitcnt lgkmcnt(8)
    v_mfma_f32_32x32x16_bf16 v[128:143], v[24:27], a[72:75], v[128:143]
    ds_read_b64_tr_b16 v[44:45], v121 offset:8192
    ds_read_b64_tr_b16 v[46:47], v121 offset:8704
    v_add_f32 v55, 1.0, v55
    v_rcp_f32 v53, v53
    v_mfma_f32_32x32x16_bf16 v[144:159], v[28:31], a[72:75], v[144:159]
    ds_read_b64_tr_b16 v[24:25], v122 offset:8192
    ds_read_b64_tr_b16 v[26:27], v122 offset:8704
    s_waitcnt vmcnt(18)
    ds_read_b64_tr_b16 v[80:81], v242 offset:24576
    v_mul_f32 v228, v228, v52
    v_rcp_f32 v54, v54
    s_waitcnt lgkmcnt(8)
    v_mfma_f32_32x32x16_bf16 v[160:175], v[32:35], a[72:75], v[160:175]
    ds_read_b64_tr_b16 v[28:29], v123 offset:8192
    ds_read_b64_tr_b16 v[30:31], v123 offset:8704
    v_mul_f32 v229, v229, v53
    v_rcp_f32 v55, v55
    v_mfma_f32_32x32x16_bf16 v[176:191], v[36:39], a[72:75], v[176:191]
    ds_read_b64_tr_b16 v[32:33], v120 offset:10240
    ds_read_b64_tr_b16 v[34:35], v120 offset:10752
    ds_read_b64_tr_b16 v[82:83], v242 offset:25600
    v_mul_f32 v230, v230, v54
    v_mul_f32 v231, v231, v55
    v_cvt_pk_bf16_f32 v114, v228, v229
    s_waitcnt lgkmcnt(8)
    v_mfma_f32_32x32x16_bf16 v[128:143], v[40:43], a[76:79], v[128:143]
    ds_read_b64_tr_b16 v[36:37], v121 offset:10240
    ds_read_b64_tr_b16 v[38:39], v121 offset:10752
    v_cvt_pk_bf16_f32 v115, v230, v231
    buffer_store_dwordx4 v[112:115], v15, s[16:19], s46 offen offset:2048 sc1
    v_mfma_f32_32x32x16_bf16 v[144:159], v[44:47], a[76:79], v[144:159]
    ds_read_b64_tr_b16 v[40:41], v122 offset:10240
    ds_read_b64_tr_b16 v[42:43], v122 offset:10752
    ds_read_b64_tr_b16 v[84:85], v243 offset:24576
    s_waitcnt lgkmcnt(8)
    v_mfma_f32_32x32x16_bf16 v[160:175], v[24:27], a[76:79], v[160:175]
    ds_read_b64_tr_b16 v[44:45], v123 offset:10240
    ds_read_b64_tr_b16 v[46:47], v123 offset:10752
    ds_read_b64_tr_b16 v[86:87], v243 offset:25600
    v_mfma_f32_32x32x16_bf16 v[176:191], v[28:31], a[76:79], v[176:191]
    ds_read_b64_tr_b16 v[24:25], v120 offset:12288
    ds_read_b64_tr_b16 v[26:27], v120 offset:12800
    s_waitcnt lgkmcnt(8)
    v_mfma_f32_32x32x16_bf16 v[128:143], v[32:35], a[80:83], v[128:143]
    ds_read_b64_tr_b16 v[28:29], v121 offset:12288
    ds_read_b64_tr_b16 v[30:31], v121 offset:12800
    v_mfma_f32_32x32x16_bf16 v[144:159], v[36:39], a[80:83], v[144:159]
    ds_read_b64_tr_b16 v[32:33], v122 offset:12288
    ds_read_b64_tr_b16 v[34:35], v122 offset:12800
    s_waitcnt lgkmcnt(7)
    v_mfma_f32_32x32x16_bf16 v[160:175], v[40:43], a[80:83], v[160:175]
    ds_read_b64_tr_b16 v[36:37], v123 offset:12288
    ds_read_b64_tr_b16 v[38:39], v123 offset:12800
    v_mfma_f32_32x32x16_bf16 v[176:191], v[44:47], a[80:83], v[176:191]
    ds_read_b64_tr_b16 v[40:41], v120 offset:14336
    ds_read_b64_tr_b16 v[42:43], v120 offset:14848
    s_waitcnt vmcnt(14)
    s_barrier
    s_add_u32 m0, s26, 122880
    s_add_u32 s37, s37, 2048
    buffer_load_dwordx4 v8, s[8:11], s37 offen sc1 lds
    s_waitcnt lgkmcnt(6)
    v_mfma_f32_32x32x16_bf16 v[128:143], v[24:27], a[84:87], v[128:143]
    ds_read_b64_tr_b16 v[44:45], v121 offset:14336
    ds_read_b64_tr_b16 v[46:47], v121 offset:14848
    buffer_load_dwordx4 v9, s[8:11], s37 offen offset:1024 sc1 lds
    s_waitcnt vmcnt(13)
    ds_read_b64_tr_b16 v[88:89], v242 offset:32768
    v_mfma_f32_32x32x16_bf16 v[144:159], v[28:31], a[84:87], v[144:159]
    ds_read_b64_tr_b16 v[24:25], v122 offset:14336
    ds_read_b64_tr_b16 v[26:27], v122 offset:14848
    s_add_u32 m0, s26, 155648
    s_add_u32 s37, s37, 2048
    buffer_load_dwordx4 v8, s[8:11], s37 offen sc1 lds
    ds_read_b64_tr_b16 v[90:91], v242 offset:33792
    s_waitcnt lgkmcnt(8)
    v_mfma_f32_32x32x16_bf16 v[160:175], v[32:35], a[84:87], v[160:175]
    ds_read_b64_tr_b16 v[28:29], v123 offset:14336
    ds_read_b64_tr_b16 v[30:31], v123 offset:14848
    ds_read_b64_tr_b16 v[92:93], v243 offset:32768
    v_mfma_f32_32x32x16_bf16 v[176:191], v[36:39], a[84:87], v[176:191]
    ds_read_b64_tr_b16 v[32:33], v120 offset:16384
    ds_read_b64_tr_b16 v[34:35], v120 offset:16896
    buffer_load_dwordx4 v9, s[8:11], s37 offen offset:1024 sc1 lds
    ds_read_b64_tr_b16 v[94:95], v243 offset:33792
    s_waitcnt lgkmcnt(10)
    v_mfma_f32_32x32x16_bf16 v[128:143], v[40:43], a[88:91], v[128:143]
    ds_read_b64_tr_b16 v[36:37], v121 offset:16384
    ds_read_b64_tr_b16 v[38:39], v121 offset:16896
    s_add_u32 m0, s26, 0
    s_add_u32 s37, s37, 2048
    buffer_load_dwordx4 v8, s[8:11], s37 offen sc1 lds
    s_waitcnt vmcnt(14)
    ds_read_b64_tr_b16 v[96:97], v242 offset:40960
    v_mfma_f32_32x32x16_bf16 v[144:159], v[44:47], a[88:91], v[144:159]
    ds_read_b64_tr_b16 v[40:41], v122 offset:16384
    ds_read_b64_tr_b16 v[42:43], v122 offset:16896
    s_waitcnt lgkmcnt(9)
    v_mfma_f32_32x32x16_bf16 v[160:175], v[24:27], a[88:91], v[160:175]
    ds_read_b64_tr_b16 v[44:45], v123 offset:16384
    ds_read_b64_tr_b16 v[46:47], v123 offset:16896
    buffer_load_dwordx4 v9, s[8:11], s37 offen offset:1024 sc1 lds
    ds_read_b64_tr_b16 v[98:99], v242 offset:41984
    v_mfma_f32_32x32x16_bf16 v[176:191], v[28:31], a[88:91], v[176:191]
    ds_read_b64_tr_b16 v[24:25], v120 offset:18432
    ds_read_b64_tr_b16 v[26:27], v120 offset:18944
    s_add_u32 m0, s26, 49152
    s_add_u32 s37, s37, 2048
    buffer_load_dwordx4 v8, s[8:11], s37 offen sc1 lds
    s_waitcnt lgkmcnt(8)
    v_mfma_f32_32x32x16_bf16 v[128:143], v[32:35], a[92:95], v[128:143]
    ds_read_b64_tr_b16 v[28:29], v121 offset:18432
    ds_read_b64_tr_b16 v[30:31], v121 offset:18944
    ds_read_b64_tr_b16 v[100:101], v243 offset:40960
    v_mfma_f32_32x32x16_bf16 v[144:159], v[36:39], a[92:95], v[144:159]
    ds_read_b64_tr_b16 v[32:33], v122 offset:18432
    ds_read_b64_tr_b16 v[34:35], v122 offset:18944
    buffer_load_dwordx4 v9, s[8:11], s37 offen offset:1024 sc1 lds
    ds_read_b64_tr_b16 v[102:103], v243 offset:41984
    s_waitcnt lgkmcnt(9)
    v_mfma_f32_32x32x16_bf16 v[160:175], v[40:43], a[92:95], v[160:175]
    ds_read_b64_tr_b16 v[36:37], v123 offset:18432
    ds_read_b64_tr_b16 v[38:39], v123 offset:18944
    s_add_u32 m0, s26, 40960
    s_nop 0
    buffer_load_dwordx4 v8, s[8:11], s38 offen sc1 lds
    s_waitcnt vmcnt(16)
    ds_read_b64_tr_b16 v[104:105], v242 offset:49152
    v_mfma_f32_32x32x16_bf16 v[176:191], v[44:47], a[92:95], v[176:191]
    ds_read_b64_tr_b16 v[40:41], v120 offset:20480
    ds_read_b64_tr_b16 v[42:43], v120 offset:20992
    s_waitcnt lgkmcnt(9)
    v_mfma_f32_32x32x16_bf16 v[128:143], v[24:27], a[96:99], v[128:143]
    ds_read_b64_tr_b16 v[44:45], v121 offset:20480
    ds_read_b64_tr_b16 v[46:47], v121 offset:20992
    buffer_load_dwordx4 v9, s[8:11], s38 offen offset:1024 sc1 lds
    ds_read_b64_tr_b16 v[106:107], v242 offset:50176
    v_mfma_f32_32x32x16_bf16 v[144:159], v[28:31], a[96:99], v[144:159]
    ds_read_b64_tr_b16 v[24:25], v122 offset:20480
    ds_read_b64_tr_b16 v[26:27], v122 offset:20992
    s_add_u32 m0, s26, 90112
    s_add_u32 s38, s38, 2048
    buffer_load_dwordx4 v8, s[8:11], s38 offen sc1 lds
    s_waitcnt lgkmcnt(8)
    v_mfma_f32_32x32x16_bf16 v[160:175], v[32:35], a[96:99], v[160:175]
    ds_read_b64_tr_b16 v[28:29], v123 offset:20480
    ds_read_b64_tr_b16 v[30:31], v123 offset:20992
    ds_read_b64_tr_b16 v[108:109], v243 offset:49152
    v_mfma_f32_32x32x16_bf16 v[176:191], v[36:39], a[96:99], v[176:191]
    ds_read_b64_tr_b16 v[32:33], v120 offset:22528
    ds_read_b64_tr_b16 v[34:35], v120 offset:23040
    buffer_load_dwordx4 v9, s[8:11], s38 offen offset:1024 sc1 lds
    ds_read_b64_tr_b16 v[110:111], v243 offset:50176
    s_waitcnt lgkmcnt(9)
    v_mfma_f32_32x32x16_bf16 v[128:143], v[40:43], a[100:103], v[128:143]
    ds_read_b64_tr_b16 v[36:37], v121 offset:22528
    ds_read_b64_tr_b16 v[38:39], v121 offset:23040
    s_add_u32 m0, s26, 98304
    s_add_u32 s38, s38, 2048
    buffer_load_dwordx4 v8, s[8:11], s38 offen sc1 lds
    s_waitcnt vmcnt(18)
    ds_read_b64_tr_b16 a[224:225], v244 offset:0
    v_mfma_f32_32x32x16_bf16 v[144:159], v[44:47], a[100:103], v[144:159]
    ds_read_b64_tr_b16 v[40:41], v122 offset:22528
    ds_read_b64_tr_b16 v[42:43], v122 offset:23040
    s_waitcnt lgkmcnt(9)
    v_mfma_f32_32x32x16_bf16 v[160:175], v[24:27], a[100:103], v[160:175]
    ds_read_b64_tr_b16 v[44:45], v123 offset:22528
    ds_read_b64_tr_b16 v[46:47], v123 offset:23040
    buffer_load_dwordx4 v9, s[8:11], s38 offen offset:1024 sc1 lds
    ds_read_b64_tr_b16 a[226:227], v244 offset:1024
    v_mfma_f32_32x32x16_bf16 v[176:191], v[28:31], a[100:103], v[176:191]
    ds_read_b64_tr_b16 v[24:25], v120 offset:24576
    ds_read_b64_tr_b16 v[26:27], v120 offset:25088
    s_add_u32 m0, s26, 106496
    s_add_u32 s38, s38, 2048
    buffer_load_dwordx4 v8, s[8:11], s38 offen sc1 lds
    s_waitcnt lgkmcnt(8)
    v_mfma_f32_32x32x16_bf16 v[128:143], v[32:35], a[104:107], v[128:143]
    ds_read_b64_tr_b16 v[28:29], v121 offset:24576
    ds_read_b64_tr_b16 v[30:31], v121 offset:25088
    ds_read_b64_tr_b16 a[228:229], v245 offset:0
    v_mfma_f32_32x32x16_bf16 v[144:159], v[36:39], a[104:107], v[144:159]
    ds_read_b64_tr_b16 v[32:33], v122 offset:24576
    ds_read_b64_tr_b16 v[34:35], v122 offset:25088
    buffer_load_dwordx4 v9, s[8:11], s38 offen offset:1024 sc1 lds
    ds_read_b64_tr_b16 a[230:231], v245 offset:1024
    s_waitcnt lgkmcnt(9)
    v_mfma_f32_32x32x16_bf16 v[160:175], v[40:43], a[104:107], v[160:175]
    ds_read_b64_tr_b16 v[36:37], v123 offset:24576
    ds_read_b64_tr_b16 v[38:39], v123 offset:25088
    s_add_u32 m0, s26, 114688
    s_add_u32 s38, s38, 2048
    buffer_load_dwordx4 v8, s[8:11], s38 offen sc1 lds
    s_waitcnt vmcnt(20)
    ds_read_b64_tr_b16 a[232:233], v244 offset:8192
    v_mfma_f32_32x32x16_bf16 v[176:191], v[44:47], a[104:107], v[176:191]
    ds_read_b64_tr_b16 v[40:41], v120 offset:26624
    ds_read_b64_tr_b16 v[42:43], v120 offset:27136
    s_waitcnt lgkmcnt(9)
    v_mfma_f32_32x32x16_bf16 v[128:143], v[24:27], a[108:111], v[128:143]
    ds_read_b64_tr_b16 v[44:45], v121 offset:26624
    ds_read_b64_tr_b16 v[46:47], v121 offset:27136
    buffer_load_dwordx4 v9, s[8:11], s38 offen offset:1024 sc1 lds
    ds_read_b64_tr_b16 a[234:235], v244 offset:9216
    s_waitcnt vmcnt(18)
    s_mov_b64 exec, 1
    s_cmp_eq_u32 s101, 0
    s_cbranch_scc1 L_ls3a
    buffer_store_dword v20, v21, s[52:55], s33 offen offset:1536 sc1
    s_branch L_ls3b
L_ls3a:
    buffer_store_dword v20, v21, s[52:55], s33 offen offset:1536
L_ls3b:
    s_mov_b64 exec, -1
    v_mfma_f32_32x32x16_bf16 v[144:159], v[28:31], a[108:111], v[144:159]
    ds_read_b64_tr_b16 v[24:25], v122 offset:26624
    ds_read_b64_tr_b16 v[26:27], v122 offset:27136
    s_waitcnt lgkmcnt(8)
    v_mfma_f32_32x32x16_bf16 v[160:175], v[32:35], a[108:111], v[160:175]
    ds_read_b64_tr_b16 v[28:29], v123 offset:26624
    ds_read_b64_tr_b16 v[30:31], v123 offset:27136
    s_add_u32 m0, s26, 131072
    s_add_u32 s38, s38, 2048
    buffer_load_dwordx4 v8, s[8:11], s38 offen sc1 lds
    ds_read_b64_tr_b16 a[236:237], v245 offset:8192
    v_mfma_f32_32x32x16_bf16 v[176:191], v[36:39], a[108:111], v[176:191]
    ds_read_b64_tr_b16 v[32:33], v120 offset:28672
    ds_read_b64_tr_b16 v[34:35], v120 offset:29184
    s_barrier
    buffer_load_dwordx4 v9, s[8:11], s38 offen offset:1024 sc1 lds
    ds_read_b64_tr_b16 a[238:239], v245 offset:9216
    s_waitcnt lgkmcnt(9)
    v_mfma_f32_32x32x16_bf16 v[128:143], v[40:43], a[112:115], v[128:143]
    ds_read_b64_tr_b16 v[36:37], v121 offset:28672
    ds_read_b64_tr_b16 v[38:39], v121 offset:29184
    ds_read_b64_tr_b16 a[240:241], v244 offset:16384
    v_mfma_f32_32x32x16_bf16 v[144:159], v[44:47], a[112:115], v[144:159]
    ds_read_b64_tr_b16 v[40:41], v122 offset:28672
    ds_read_b64_tr_b16 v[42:43], v122 offset:29184
    s_waitcnt lgkmcnt(9)
    v_mfma_f32_32x32x16_bf16 v[160:175], v[24:27], a[112:115], v[160:175]
    ds_read_b64_tr_b16 v[44:45], v123 offset:28672
    ds_read_b64_tr_b16 v[46:47], v123 offset:29184
    ds_read_b64_tr_b16 a[242:243], v244 offset:17408
    v_mfma_f32_32x32x16_bf16 v[176:191], v[28:31], a[112:115], v[176:191]
    ds_read_b64_tr_b16 v[24:25], v120 offset:30720
    ds_read_b64_tr_b16 v[26:27], v120 offset:31232
    s_waitcnt lgkmcnt(8)
    v_mfma_f32_32x32x16_bf16 v[128:143], v[32:35], a[116:119], v[128:143]
    ds_read_b64_tr_b16 v[28:29], v121 offset:30720
    ds_read_b64_tr_b16 v[30:31], v121 offset:31232
    s_add_u32 m0, s26, 139264
    s_add_u32 s38, s38, 2048
    buffer_load_dwordx4 v8, s[8:11], s38 offen sc1 lds
    ds_read_b64_tr_b16 a[244:245], v245 offset:16384
    v_mfma_f32_32x32x16_bf16 v[144:159], v[36:39], a[116:119], v[144:159]
    ds_read_b64_tr_b16 v[32:33], v122 offset:30720
    ds_read_b64_tr_b16 v[34:35], v122 offset:31232
    buffer_load_dwordx4 v9, s[8:11], s38 offen offset:1024 sc1 lds
    ds_read_b64_tr_b16 a[246:247], v245 offset:17408
    s_waitcnt lgkmcnt(9)
    v_mfma_f32_32x32x16_bf16 v[160:175], v[40:43], a[116:119], v[160:175]
    ds_read_b64_tr_b16 v[36:37], v123 offset:30720
    ds_read_b64_tr_b16 v[38:39], v123 offset:31232
    v_mfma_f32_32x32x16_bf16 v[176:191], v[44:47], a[116:119], v[176:191]
    ds_read_b64_tr_b16 v[40:41], v120 offset:32768
    ds_read_b64_tr_b16 v[42:43], v120 offset:33280
    s_waitcnt lgkmcnt(8)
    v_mfma_f32_32x32x16_bf16 v[128:143], v[24:27], a[120:123], v[128:143]
    ds_read_b64_tr_b16 v[44:45], v121 offset:32768
    ds_read_b64_tr_b16 v[46:47], v121 offset:33280
    v_mfma_f32_32x32x16_bf16 v[144:159], v[28:31], a[120:123], v[144:159]
    ds_read_b64_tr_b16 v[24:25], v122 offset:32768
    ds_read_b64_tr_b16 v[26:27], v122 offset:33280
    s_waitcnt lgkmcnt(6)
    v_mfma_f32_32x32x16_bf16 v[160:175], v[32:35], a[120:123], v[160:175]
    ds_read_b64_tr_b16 v[28:29], v123 offset:32768
    ds_read_b64_tr_b16 v[30:31], v123 offset:33280
    s_add_u32 m0, s26, 147456
    s_add_u32 s38, s38, 2048
    buffer_load_dwordx4 v8, s[8:11], s38 offen sc1 lds
    v_mfma_f32_32x32x16_bf16 v[176:191], v[36:39], a[120:123], v[176:191]
    buffer_load_dwordx4 v9, s[8:11], s38 offen offset:1024 sc1 lds
    s_waitcnt lgkmcnt(4)
    v_mfma_f32_32x32x16_bf16 v[128:143], v[40:43], a[124:127], v[128:143]
    s_add_u32 m0, s26, 8192
    s_add_u32 s38, s38, 2048
    buffer_load_dwordx4 v8, s[8:11], s38 offen sc1 lds
    v_mfma_f32_32x32x16_bf16 v[144:159], v[44:47], a[124:127], v[144:159]
    s_waitcnt lgkmcnt(0)
    v_mfma_f32_32x32x16_bf16 v[160:175], v[24:27], a[124:127], v[160:175]
    buffer_load_dwordx4 v9, s[8:11], s38 offen offset:1024 sc1 lds
    v_mfma_f32_32x32x16_bf16 v[176:191], v[28:31], a[124:127], v[176:191]
    s_barrier
    s_add_u32 m0, s26, 16384
    s_add_u32 s38, s38, 2048
    buffer_load_dwordx4 v8, s[8:11], s38 offen sc1 lds
    s_mov_b64 exec, 0xff
    buffer_load_dword v22, v13, s[52:55], s25 offen offset:1536 sc1
    s_mov_b64 exec, -1
    s_mov_b32 s34, 1.0
    s_mov_b32 s35, 1.0
    v_pk_mul_f32 v[48:49], v[128:129], v[128:129]
    v_pk_mul_f32 v[50:51], v[130:131], v[130:131]
    v_pk_mul_f32 v[52:53], v[132:133], v[132:133]
    v_pk_mul_f32 v[54:55], v[134:135], v[134:135]
    buffer_load_dwordx4 v9, s[8:11], s38 offen offset:1024 sc1 lds
    v_pk_fma_f32 v[48:49], v[48:49], s[44:45], v[2:3]
    v_pk_fma_f32 v[50:51], v[50:51], s[44:45], v[2:3]
    v_pk_fma_f32 v[52:53], v[52:53], s[44:45], v[2:3]
    v_pk_fma_f32 v[54:55], v[54:55], s[44:45], v[2:3]
    v_pk_mul_f32 v[48:49], v[48:49], v[128:129]
    v_pk_mul_f32 v[50:51], v[50:51], v[130:131]
    s_add_u32 m0, s26, 57344
    s_add_u32 s38, s38, 2048
    buffer_load_dwordx4 v8, s[8:11], s38 offen sc1 lds
    v_pk_mul_f32 v[52:53], v[52:53], v[132:133]
    v_pk_mul_f32 v[54:55], v[54:55], v[134:135]
    v_exp_f32 v48, v48
    v_exp_f32 v49, v49
    v_exp_f32 v50, v50
    v_exp_f32 v51, v51
    buffer_load_dwordx4 v9, s[8:11], s38 offen offset:1024 sc1 lds
    v_exp_f32 v52, v52
    v_exp_f32 v53, v53
    v_exp_f32 v54, v54
    v_exp_f32 v55, v55
    v_pk_mul_f32 v[128:129], v[128:129], v[136:137]
    v_pk_mul_f32 v[130:131], v[130:131], v[138:139]
    s_add_u32 m0, s26, 65536
    s_add_u32 s38, s38, 2048
    buffer_load_dwordx4 v8, s[8:11], s38 offen sc1 lds
    v_pk_mul_f32 v[132:133], v[132:133], v[140:141]
    v_pk_mul_f32 v[134:135], v[134:135], v[142:143]
    v_pk_add_f32 v[48:49], v[48:49], s[34:35]
    v_pk_add_f32 v[50:51], v[50:51], s[34:35]
    v_pk_add_f32 v[52:53], v[52:53], s[34:35]
    v_pk_add_f32 v[54:55], v[54:55], s[34:35]
    buffer_load_dwordx4 v9, s[8:11], s38 offen offset:1024 sc1 lds
    v_rcp_f32 v48, v48
    v_rcp_f32 v49, v49
    v_rcp_f32 v50, v50
    v_rcp_f32 v51, v51
    v_rcp_f32 v52, v52
    v_rcp_f32 v53, v53
    s_add_u32 m0, s26, 24576
    s_add_u32 s38, s38, 2048
    buffer_load_dwordx4 v8, s[8:11], s38 offen sc1 lds
    v_rcp_f32 v54, v54
    v_rcp_f32 v55, v55
    v_pk_mul_f32 v[128:129], v[128:129], v[48:49]
    v_pk_mul_f32 v[130:131], v[130:131], v[50:51]
    v_pk_mul_f32 v[132:133], v[132:133], v[52:53]
    v_pk_mul_f32 v[134:135], v[134:135], v[54:55]
    buffer_load_dwordx4 v9, s[8:11], s38 offen offset:1024 sc1 lds
    v_cvt_pk_bf16_f32 v64, v128, v129
    v_cvt_pk_bf16_f32 v65, v130, v131
    v_cvt_pk_bf16_f32 v66, v132, v133
    v_cvt_pk_bf16_f32 v67, v134, v135
    buffer_store_dwordx4 v[64:67], v15, s[16:19], s47 offen sc1
    v_pk_mul_f32 v[48:49], v[144:145], v[144:145]
    v_pk_mul_f32 v[50:51], v[146:147], v[146:147]
    v_pk_mul_f32 v[52:53], v[148:149], v[148:149]
    v_pk_mul_f32 v[54:55], v[150:151], v[150:151]
    s_add_u32 m0, s26, 32768
    s_add_u32 s38, s38, 2048
    buffer_load_dwordx4 v8, s[8:11], s38 offen sc1 lds
    v_pk_fma_f32 v[48:49], v[48:49], s[44:45], v[2:3]
    v_pk_fma_f32 v[50:51], v[50:51], s[44:45], v[2:3]
    v_pk_fma_f32 v[52:53], v[52:53], s[44:45], v[2:3]
    v_pk_fma_f32 v[54:55], v[54:55], s[44:45], v[2:3]
    v_pk_mul_f32 v[48:49], v[48:49], v[144:145]
    v_pk_mul_f32 v[50:51], v[50:51], v[146:147]
    buffer_load_dwordx4 v9, s[8:11], s38 offen offset:1024 sc1 lds
    v_pk_mul_f32 v[52:53], v[52:53], v[148:149]
    v_pk_mul_f32 v[54:55], v[54:55], v[150:151]
    v_exp_f32 v48, v48
    v_exp_f32 v49, v49
    v_exp_f32 v50, v50
    v_exp_f32 v51, v51
    s_add_u32 m0, s26, 73728
    s_add_u32 s38, s38, 2048
    buffer_load_dwordx4 v8, s[8:11], s38 offen sc1 lds
    v_exp_f32 v52, v52
    v_exp_f32 v53, v53
    v_exp_f32 v54, v54
    v_exp_f32 v55, v55
    v_pk_mul_f32 v[144:145], v[144:145], v[152:153]
    v_pk_mul_f32 v[146:147], v[146:147], v[154:155]
    buffer_load_dwordx4 v9, s[8:11], s38 offen offset:1024 sc1 lds
    v_pk_mul_f32 v[148:149], v[148:149], v[156:157]
    v_pk_mul_f32 v[150:151], v[150:151], v[158:159]
    v_pk_add_f32 v[48:49], v[48:49], s[34:35]
    v_pk_add_f32 v[50:51], v[50:51], s[34:35]
    v_pk_add_f32 v[52:53], v[52:53], s[34:35]
    v_pk_add_f32 v[54:55], v[54:55], s[34:35]
    s_add_u32 m0, s26, 81920
    s_add_u32 s38, s38, 2048
    buffer_load_dwordx4 v8, s[8:11], s38 offen sc1 lds
    v_rcp_f32 v48, v48
    v_rcp_f32 v49, v49
    v_rcp_f32 v50, v50
    v_rcp_f32 v51, v51
    v_rcp_f32 v52, v52
    v_rcp_f32 v53, v53
    buffer_load_dwordx4 v9, s[8:11], s38 offen offset:1024 sc1 lds
    v_rcp_f32 v54, v54
    v_rcp_f32 v55, v55
    v_pk_mul_f32 v[144:145], v[144:145], v[48:49]
    v_pk_mul_f32 v[146:147], v[146:147], v[50:51]
    v_pk_mul_f32 v[148:149], v[148:149], v[52:53]
    v_pk_mul_f32 v[150:151], v[150:151], v[54:55]
    v_cvt_pk_bf16_f32 v68, v144, v145
    v_cvt_pk_bf16_f32 v69, v146, v147
    v_cvt_pk_bf16_f32 v70, v148, v149
    v_cvt_pk_bf16_f32 v71, v150, v151
    s_add_u32 s47, s47, 1024
    buffer_store_dwordx4 v[68:71], v15, s[16:19], s47 offen sc1
    v_pk_mul_f32 v[48:49], v[160:161], v[160:161]
    v_pk_mul_f32 v[50:51], v[162:163], v[162:163]
    v_pk_mul_f32 v[52:53], v[164:165], v[164:165]
    v_pk_mul_f32 v[54:55], v[166:167], v[166:167]
    v_pk_fma_f32 v[48:49], v[48:49], s[44:45], v[2:3]
    v_pk_fma_f32 v[50:51], v[50:51], s[44:45], v[2:3]
    v_pk_fma_f32 v[52:53], v[52:53], s[44:45], v[2:3]
    v_pk_fma_f32 v[54:55], v[54:55], s[44:45], v[2:3]
    v_pk_mul_f32 v[48:49], v[48:49], v[160:161]
    v_pk_mul_f32 v[50:51], v[50:51], v[162:163]
    v_pk_mul_f32 v[52:53], v[52:53], v[164:165]
    v_pk_mul_f32 v[54:55], v[54:55], v[166:167]
    v_exp_f32 v48, v48
    v_exp_f32 v49, v49
    v_exp_f32 v50, v50
    v_exp_f32 v51, v51
    v_exp_f32 v52, v52
    v_exp_f32 v53, v53
    v_exp_f32 v54, v54
    v_exp_f32 v55, v55
    v_pk_mul_f32 v[160:161], v[160:161], v[168:169]
    v_pk_mul_f32 v[162:163], v[162:163], v[170:171]
    v_pk_mul_f32 v[164:165], v[164:165], v[172:173]
    v_pk_mul_f32 v[166:167], v[166:167], v[174:175]
    v_pk_add_f32 v[48:49], v[48:49], s[34:35]
    v_pk_add_f32 v[50:51], v[50:51], s[34:35]
    v_pk_add_f32 v[52:53], v[52:53], s[34:35]
    v_pk_add_f32 v[54:55], v[54:55], s[34:35]
    v_rcp_f32 v48, v48
    v_rcp_f32 v49, v49
    v_rcp_f32 v50, v50
    v_rcp_f32 v51, v51
    v_rcp_f32 v52, v52
    v_rcp_f32 v53, v53
    v_rcp_f32 v54, v54
    v_rcp_f32 v55, v55
    v_pk_mul_f32 v[160:161], v[160:161], v[48:49]
    v_pk_mul_f32 v[162:163], v[162:163], v[50:51]
    v_pk_mul_f32 v[164:165], v[164:165], v[52:53]
    v_pk_mul_f32 v[166:167], v[166:167], v[54:55]
    v_cvt_pk_bf16_f32 v64, v160, v161
    v_cvt_pk_bf16_f32 v65, v162, v163
    v_cvt_pk_bf16_f32 v66, v164, v165
    v_cvt_pk_bf16_f32 v67, v166, v167
    s_add_u32 s47, s47, 1024
    buffer_store_dwordx4 v[64:67], v15, s[16:19], s47 offen sc1
    s_mov_b32 s51, 32768
    s_waitcnt vmcnt(16)
    s_mov_b64 exec, 0xff
    s_branch L_f2_chk
L_f2:
    s_sleep 1
L_f2_go:
    buffer_load_dword v22, v13, s[52:55], s25 offen offset:1536 sc1
    s_waitcnt vmcnt(0)
L_f2_chk:
    v_cmp_ne_u32 vcc, s50, v22
    s_sub_u32 s51, s51, 1
    s_cbranch_scc1 L_f2_ok
    s_cbranch_vccnz L_f2
L_f2_ok:
    s_mov_b64 exec, -1
    v_pk_mul_f32 v[48:49], v[176:177], v[176:177]
    v_pk_mul_f32 v[50:51], v[178:179], v[178:179]
    v_pk_mul_f32 v[52:53], v[180:181], v[180:181]
    v_pk_mul_f32 v[54:55], v[182:183], v[182:183]
    v_pk_fma_f32 v[48:49], v[48:49], s[44:45], v[2:3]
    v_pk_fma_f32 v[50:51], v[50:51], s[44:45], v[2:3]
    v_pk_fma_f32 v[52:53], v[52:53], s[44:45], v[2:3]
    v_pk_fma_f32 v[54:55], v[54:55], s[44:45], v[2:3]
    v_pk_mul_f32 v[48:49], v[48:49], v[176:177]
    v_pk_mul_f32 v[50:51], v[50:51], v[178:179]
    v_pk_mul_f32 v[52:53], v[52:53], v[180:181]
    v_pk_mul_f32 v[54:55], v[54:55], v[182:183]
    v_exp_f32 v48, v48
    v_exp_f32 v49, v49
    v_exp_f32 v50, v50
    v_exp_f32 v51, v51
    v_exp_f32 v52, v52
    v_exp_f32 v53, v53
    v_exp_f32 v54, v54
    v_exp_f32 v55, v55
    v_pk_mul_f32 v[176:177], v[176:177], v[184:185]
    v_pk_mul_f32 v[178:179], v[178:179], v[186:187]
    v_pk_mul_f32 v[180:181], v[180:181], v[188:189]
    v_pk_mul_f32 v[182:183], v[182:183], v[190:191]
    v_pk_add_f32 v[48:49], v[48:49], s[34:35]
    v_pk_add_f32 v[50:51], v[50:51], s[34:35]
    v_pk_add_f32 v[52:53], v[52:53], s[34:35]
    v_pk_add_f32 v[54:55], v[54:55], s[34:35]
    v_rcp_f32 v48, v48
    v_rcp_f32 v49, v49
    v_rcp_f32 v50, v50
    v_rcp_f32 v51, v51
    v_rcp_f32 v52, v52
    v_rcp_f32 v53, v53
    v_rcp_f32 v54, v54
    v_rcp_f32 v55, v55
    v_pk_mul_f32 v[176:177], v[176:177], v[48:49]
    v_pk_mul_f32 v[178:179], v[178:179], v[50:51]
    v_pk_mul_f32 v[180:181], v[180:181], v[52:53]
    v_pk_mul_f32 v[182:183], v[182:183], v[54:55]
    v_cvt_pk_bf16_f32 v68, v176, v177
    v_cvt_pk_bf16_f32 v69, v178, v179
    v_cvt_pk_bf16_f32 v70, v180, v181
    v_cvt_pk_bf16_f32 v71, v182, v183
    s_add_u32 s47, s47, 1024
    buffer_store_dwordx4 v[68:71], v15, s[16:19], s47 offen sc1
    v_and_b32 v4, 31, v1
    v_lshrrev_b32 v5, 5, v1
    v_lshlrev_b32 v10, 10, v4
    v_lshl_add_u32 v10, v5, 4, v10
    s_lshr_b32 s46, s3, 1
    s_lshl_b32 s46, s46, 15
    s_and_b32 s47, s3, 1
    s_lshl_b32 s47, s47, 6
    s_add_u32 s39, s39, s46
    s_add_u32 s39, s39, s47
    s_add_u32 s46, s39, 0
    buffer_load_dwordx4 a[128:131], v250, s[16:19], s5 offen offset:0 sc1
    buffer_load_dwordx4 a[132:135], v16, s[16:19], s5 offen offset:0 sc1
    buffer_load_dwordx4 a[136:139], v250, s[16:19], s5 offen offset:1024 sc1
    buffer_load_dwordx4 a[140:143], v16, s[16:19], s5 offen offset:1024 sc1
    buffer_load_dwordx4 a[144:147], v250, s[16:19], s5 offen offset:2048 sc1
    buffer_load_dwordx4 a[148:151], v16, s[16:19], s5 offen offset:2048 sc1
    buffer_load_dwordx4 a[152:155], v250, s[16:19], s5 offen offset:3072 sc1
    buffer_load_dwordx4 a[156:159], v16, s[16:19], s5 offen offset:3072 sc1
    s_add_u32 s5, s5, 0x1000
    buffer_load_dwordx4 a[160:163], v250, s[16:19], s5 offen offset:0 sc1
    buffer_load_dwordx4 a[164:167], v16, s[16:19], s5 offen offset:0 sc1
    buffer_load_dwordx4 a[168:171], v250, s[16:19], s5 offen offset:1024 sc1
    buffer_load_dwordx4 a[172:175], v16, s[16:19], s5 offen offset:1024 sc1
    s_waitcnt vmcnt(12)
    s_mov_b64 exec, 1
    s_cmp_eq_u32 s101, 0
    s_cbranch_scc1 L_ls4a
    buffer_store_dword v20, v21, s[52:55], s33 offen offset:2048 sc1
    s_branch L_ls4b
L_ls4a:
    buffer_store_dword v20, v21, s[52:55], s33 offen offset:2048
L_ls4b:
    s_mov_b64 exec, -1
    s_waitcnt vmcnt(11)
    v_mfma_f32_32x32x16_bf16 v[128:143], v[72:75], a[128:131], 0
    buffer_load_dwordx4 a[176:179], v250, s[16:19], s5 offen offset:2048 sc1
    v_mfma_f32_32x32x16_bf16 v[144:159], v[72:75], a[132:135], 0
    buffer_load_dwordx4 a[180:183], v16, s[16:19], s5 offen offset:2048 sc1
    v_mfma_f32_32x32x16_bf16 v[160:175], v[76:79], a[128:131], 0
    buffer_load_dwordx4 a[184:187], v250, s[16:19], s5 offen offset:3072 sc1
    v_mfma_f32_32x32x16_bf16 v[176:191], v[76:79], a[132:135], 0
    buffer_load_dwordx4 a[188:191], v16, s[16:19], s5 offen offset:3072 sc1
    s_waitcnt vmcnt(13)
    v_mfma_f32_32x32x16_bf16 v[128:143], v[80:83], a[136:139], v[128:143]
    s_add_u32 s5, s5, 0x1000
    buffer_load_dwordx4 a[192:195], v250, s[16:19], s5 offen offset:0 sc1
    v_mfma_f32_32x32x16_bf16 v[144:159], v[80:83], a[140:143], v[144:159]
    buffer_load_dwordx4 a[196:199], v16, s[16:19], s5 offen offset:0 sc1
    v_mfma_f32_32x32x16_bf16 v[160:175], v[84:87], a[136:139], v[160:175]
    buffer_load_dwordx4 a[200:203], v250, s[16:19], s5 offen offset:1024 sc1
    v_mfma_f32_32x32x16_bf16 v[176:191], v[84:87], a[140:143], v[176:191]
    buffer_load_dwordx4 a[204:207], v16, s[16:19], s5 offen offset:1024 sc1
    s_waitcnt vmcnt(15)
    v_mfma_f32_32x32x16_bf16 v[128:143], v[88:91], a[144:147], v[128:143]
    buffer_load_dwordx4 a[208:211], v250, s[16:19], s5 offen offset:2048 sc1
    v_mfma_f32_32x32x16_bf16 v[144:159], v[88:91], a[148:151], v[144:159]
    buffer_load_dwordx4 a[212:215], v16, s[16:19], s5 offen offset:2048 sc1
    v_mfma_f32_32x32x16_bf16 v[160:175], v[92:95], a[144:147], v[160:175]
    buffer_load_dwordx4 a[216:219], v250, s[16:19], s5 offen offset:3072 sc1
    v_mfma_f32_32x32x16_bf16 v[176:191], v[92:95], a[148:151], v[176:191]
    buffer_load_dwordx4 a[220:223], v16, s[16:19], s5 offen offset:3072 sc1
    s_waitcnt vmcnt(17)
    v_mfma_f32_32x32x16_bf16 v[128:143], v[96:99], a[152:155], v[128:143]
    s_mov_b64 exec, 0xff
    buffer_load_dword v22, v13, s[52:55], s25 offen offset:2048 sc1
    s_mov_b64 exec, -1
    v_mfma_f32_32x32x16_bf16 v[144:159], v[96:99], a[156:159], v[144:159]
    v_mfma_f32_32x32x16_bf16 v[160:175], v[100:103], a[152:155], v[160:175]
    v_mfma_f32_32x32x16_bf16 v[176:191], v[100:103], a[156:159], v[176:191]
    s_waitcnt vmcnt(16)
    v_mfma_f32_32x32x16_bf16 v[128:143], v[104:107], a[160:163], v[128:143]
    v_mfma_f32_32x32x16_bf16 v[144:159], v[104:107], a[164:167], v[144:159]
    v_mfma_f32_32x32x16_bf16 v[160:175], v[108:111], a[160:163], v[160:175]
    v_mfma_f32_32x32x16_bf16 v[176:191], v[108:111], a[164:167], v[176:191]
    s_mov_b32 s51, 32768
    s_waitcnt vmcnt(0)
    s_mov_b64 exec, 0xff
    s_branch L_f3_chk
L_f3:
    s_sleep 1
L_f3_go:
    buffer_load_dword v22, v13, s[52:55], s25 offen offset:2048 sc1
    s_waitcnt vmcnt(0)
L_f3_chk:
    v_cmp_ne_u32 vcc, s50, v22
    s_sub_u32 s51, s51, 1
    s_cbranch_scc1 L_f3_ok
    s_cbranch_vccnz L_f3
L_f3_ok:
    s_mov_b64 exec, -1
    buffer_load_dwordx4 a[0:3], v251, s[16:19], s6 offen sc1
    buffer_load_dwordx4 a[4:7], v17, s[16:19], s6 offen sc1
    s_add_u32 s6, s6, 1024
    buffer_load_dwordx4 a[8:11], v251, s[16:19], s6 offen sc1
    buffer_load_dwordx4 a[12:15], v17, s[16:19], s6 offen sc1
    v_mfma_f32_32x32x16_bf16 v[128:143], a[224:227], a[168:171], v[128:143]
    v_mfma_f32_32x32x16_bf16 v[144:159], a[224:227], a[172:175], v[144:159]
    s_add_u32 s6, s6, 1024
    buffer_load_dwordx4 a[16:19], v251, s[16:19], s6 offen sc1
    v_mfma_f32_32x32x16_bf16 v[160:175], a[228:231], a[168:171], v[160:175]
    v_mfma_f32_32x32x16_bf16 v[176:191], a[228:231], a[172:175], v[176:191]
    buffer_load_dwordx4 a[20:23], v17, s[16:19], s6 offen sc1
    v_mfma_f32_32x32x16_bf16 v[128:143], a[232:235], a[176:179], v[128:143]
    ds_read_b64_tr_b16 v[40:41], v242 offset:57344
    ds_read_b64_tr_b16 v[42:43], v242 offset:58368
    ds_read_b64_tr_b16 v[44:45], v243 offset:57344
    ds_read_b64_tr_b16 v[46:47], v243 offset:58368
    v_mfma_f32_32x32x16_bf16 v[144:159], a[232:235], a[180:183], v[144:159]
    s_add_u32 s6, s6, 1024
    buffer_load_dwordx4 a[24:27], v251, s[16:19], s6 offen sc1
    v_mfma_f32_32x32x16_bf16 v[160:175], a[236:239], a[176:179], v[160:175]
    v_mfma_f32_32x32x16_bf16 v[176:191], a[236:239], a[180:183], v[176:191]
    buffer_load_dwordx4 a[28:31], v17, s[16:19], s6 offen sc1
    v_mfma_f32_32x32x16_bf16 v[128:143], a[240:243], a[184:187], v[128:143]
    ds_read_b64_tr_b16 v[24:25], v244 offset:24576
    ds_read_b64_tr_b16 v[26:27], v244 offset:25600
    ds_read_b64_tr_b16 v[28:29], v245 offset:24576
    ds_read_b64_tr_b16 v[30:31], v245 offset:25600
    v_mfma_f32_32x32x16_bf16 v[144:159], a[240:243], a[188:191], v[144:159]
    s_add_u32 s6, s6, 1024
    buffer_load_dwordx4 a[32:35], v251, s[16:19], s6 offen sc1
    v_mfma_f32_32x32x16_bf16 v[160:175], a[244:247], a[184:187], v[160:175]
    v_mfma_f32_32x32x16_bf16 v[176:191], a[244:247], a[188:191], v[176:191]
    buffer_load_dwordx4 a[36:39], v17, s[16:19], s6 offen sc1
    s_waitcnt lgkmcnt(6)
    v_mfma_f32_32x32x16_bf16 v[128:143], v[40:43], a[192:195], v[128:143]
    ds_read_b64_tr_b16 v[32:33], v240 offset:0
    ds_read_b64_tr_b16 v[34:35], v240 offset:1024
    ds_read_b64_tr_b16 v[36:37], v241 offset:0
    ds_read_b64_tr_b16 v[38:39], v241 offset:1024
    v_mfma_f32_32x32x16_bf16 v[144:159], v[40:43], a[196:199], v[144:159]
    s_add_u32 s6, s6, 1024
    buffer_load_dwordx4 a[40:43], v251, s[16:19], s6 offen sc1
    s_waitcnt lgkmcnt(8)
    v_mfma_f32_32x32x16_bf16 v[160:175], v[44:47], a[192:195], v[160:175]
    v_mfma_f32_32x32x16_bf16 v[176:191], v[44:47], a[196:199], v[176:191]
    buffer_load_dwordx4 a[44:47], v17, s[16:19], s6 offen sc1
    s_waitcnt lgkmcnt(6)
    v_mfma_f32_32x32x16_bf16 v[128:143], v[24:27], a[200:203], v[128:143]
    ds_read_b64_tr_b16 v[40:41], v240 offset:49152
    ds_read_b64_tr_b16 v[42:43], v240 offset:50176
    ds_read_b64_tr_b16 v[44:45], v241 offset:49152
    ds_read_b64_tr_b16 v[46:47], v241 offset:50176
    v_mfma_f32_32x32x16_bf16 v[144:159], v[24:27], a[204:207], v[144:159]
    s_add_u32 s6, s6, 1024
    buffer_load_dwordx4 a[48:51], v251, s[16:19], s6 offen sc1
    s_waitcnt lgkmcnt(8)
    v_mfma_f32_32x32x16_bf16 v[160:175], v[28:31], a[200:203], v[160:175]
    v_mfma_f32_32x32x16_bf16 v[176:191], v[28:31], a[204:207], v[176:191]
    buffer_load_dwordx4 a[52:55], v17, s[16:19], s6 offen sc1
    s_waitcnt lgkmcnt(6)
    v_mfma_f32_32x32x16_bf16 v[128:143], v[32:35], a[208:211], v[128:143]
    ds_read_b64_tr_b16 v[24:25], v240 offset:40960
    ds_read_b64_tr_b16 v[26:27], v240 offset:41984
    ds_read_b64_tr_b16 v[28:29], v241 offset:40960
    ds_read_b64_tr_b16 v[30:31], v241 offset:41984
    v_mfma_f32_32x32x16_bf16 v[144:159], v[32:35], a[212:215], v[144:159]
    s_add_u32 s6, s6, 1024
    buffer_load_dwordx4 a[56:59], v251, s[16:19], s6 offen sc1
    s_waitcnt lgkmcnt(8)
    v_mfma_f32_32x32x16_bf16 v[160:175], v[36:39], a[208:211], v[160:175]
    v_mfma_f32_32x32x16_bf16 v[176:191], v[36:39], a[212:215], v[176:191]
    buffer_load_dwordx4 a[60:63], v17, s[16:19], s6 offen sc1
    s_waitcnt lgkmcnt(6)
    v_mfma_f32_32x32x16_bf16 v[128:143], v[40:43], a[216:219], v[128:143]
    ds_read_b64_tr_b16 v[32:33], v242 offset:24576
    ds_read_b64_tr_b16 v[34:35], v242 offset:25600
    ds_read_b64_tr_b16 v[36:37], v243 offset:24576
    ds_read_b64_tr_b16 v[38:39], v243 offset:25600
    v_mfma_f32_32x32x16_bf16 v[144:159], v[40:43], a[220:223], v[144:159]
    s_add_u32 s6, s6, 1024
    buffer_load_dwordx4 a[64:67], v251, s[16:19], s6 offen sc1
    s_waitcnt lgkmcnt(8)
    v_mfma_f32_32x32x16_bf16 v[160:175], v[44:47], a[216:219], v[160:175]
    v_mfma_f32_32x32x16_bf16 v[176:191], v[44:47], a[220:223], v[176:191]
    buffer_load_dwordx4 a[68:71], v17, s[16:19], s6 offen sc1
    s_waitcnt vmcnt(16)
    s_waitcnt lgkmcnt(6)
    v_mfma_f32_32x32x16_bf16 v[128:143], v[24:27], a[0:3], v[128:143]
    ds_read_b64_tr_b16 v[40:41], v242 offset:32768
    ds_read_b64_tr_b16 v[42:43], v242 offset:33792
    ds_read_b64_tr_b16 v[44:45], v243 offset:32768
    ds_read_b64_tr_b16 v[46:47], v243 offset:33792
    v_mfma_f32_32x32x16_bf16 v[144:159], v[24:27], a[4:7], v[144:159]
    s_add_u32 s6, s6, 1024
    buffer_load_dwordx4 a[72:75], v251, s[16:19], s6 offen sc1
    s_waitcnt lgkmcnt(8)
    v_mfma_f32_32x32x16_bf16 v[160:175], v[28:31], a[0:3], v[160:175]
    v_mfma_f32_32x32x16_bf16 v[176:191], v[28:31], a[4:7], v[176:191]
    buffer_load_dwordx4 a[76:79], v17, s[16:19], s6 offen sc1
    s_waitcnt vmcnt(16)
    s_waitcnt lgkmcnt(6)
    v_mfma_f32_32x32x16_bf16 v[128:143], v[32:35], a[8:11], v[128:143]
    ds_read_b64_tr_b16 v[24:25], v242 offset:40960
    ds_read_b64_tr_b16 v[26:27], v242 offset:41984
    ds_read_b64_tr_b16 v[28:29], v243 offset:40960
    ds_read_b64_tr_b16 v[30:31], v243 offset:41984
    v_mfma_f32_32x32x16_bf16 v[144:159], v[32:35], a[12:15], v[144:159]
    s_add_u32 s6, s6, 1024
    buffer_load_dwordx4 a[80:83], v251, s[16:19], s6 offen sc1
    s_waitcnt lgkmcnt(8)
    v_mfma_f32_32x32x16_bf16 v[160:175], v[36:39], a[8:11], v[160:175]
    v_mfma_f32_32x32x16_bf16 v[176:191], v[36:39], a[12:15], v[176:191]
    buffer_load_dwordx4 a[84:87], v17, s[16:19], s6 offen sc1
    s_waitcnt vmcnt(16)
    s_waitcnt lgkmcnt(6)
    v_mfma_f32_32x32x16_bf16 v[128:143], v[40:43], a[16:19], v[128:143]
    ds_read_b64_tr_b16 v[32:33], v242 offset:49152
    ds_read_b64_tr_b16 v[34:35], v242 offset:50176
    ds_read_b64_tr_b16 v[36:37], v243 offset:49152
    ds_read_b64_tr_b16 v[38:39], v243 offset:50176
    v_mfma_f32_32x32x16_bf16 v[144:159], v[40:43], a[20:23], v[144:159]
    s_add_u32 s6, s6, 1024
    buffer_load_dwordx4 a[88:91], v251, s[16:19], s6 offen sc1
    s_waitcnt lgkmcnt(8)
    v_mfma_f32_32x32x16_bf16 v[160:175], v[44:47], a[16:19], v[160:175]
    v_mfma_f32_32x32x16_bf16 v[176:191], v[44:47], a[20:23], v[176:191]
    buffer_load_dwordx4 a[92:95], v17, s[16:19], s6 offen sc1
    s_waitcnt vmcnt(16)
    s_waitcnt lgkmcnt(6)
    v_mfma_f32_32x32x16_bf16 v[128:143], v[24:27], a[24:27], v[128:143]
    ds_read_b64_tr_b16 v[40:41], v244 offset:0
    ds_read_b64_tr_b16 v[42:43], v244 offset:1024
    ds_read_b64_tr_b16 v[44:45], v245 offset:0
    ds_read_b64_tr_b16 v[46:47], v245 offset:1024
    v_mfma_f32_32x32x16_bf16 v[144:159], v[24:27], a[28:31], v[144:159]
    s_add_u32 s6, s6, 1024
    buffer_load_dwordx4 a[96:99], v251, s[16:19], s6 offen sc1
    s_waitcnt lgkmcnt(8)
    v_mfma_f32_32x32x16_bf16 v[160:175], v[28:31], a[24:27], v[160:175]
    v_mfma_f32_32x32x16_bf16 v[176:191], v[28:31], a[28:31], v[176:191]
    buffer_load_dwordx4 a[100:103], v17, s[16:19], s6 offen sc1
    s_waitcnt vmcnt(16)
    s_waitcnt lgkmcnt(6)
    v_mfma_f32_32x32x16_bf16 v[128:143], v[32:35], a[32:35], v[128:143]
    ds_read_b64_tr_b16 v[24:25], v244 offset:8192
    ds_read_b64_tr_b16 v[26:27], v244 offset:9216
    ds_read_b64_tr_b16 v[28:29], v245 offset:8192
    ds_read_b64_tr_b16 v[30:31], v245 offset:9216
    v_mfma_f32_32x32x16_bf16 v[144:159], v[32:35], a[36:39], v[144:159]
    s_add_u32 s6, s6, 1024
    buffer_load_dwordx4 a[104:107], v251, s[16:19], s6 offen sc1
    s_waitcnt lgkmcnt(8)
    v_mfma_f32_32x32x16_bf16 v[160:175], v[36:39], a[32:35], v[160:175]
    v_mfma_f32_32x32x16_bf16 v[176:191], v[36:39], a[36:39], v[176:191]
    buffer_load_dwordx4 a[108:111], v17, s[16:19], s6 offen sc1
    s_waitcnt vmcnt(16)
    s_waitcnt lgkmcnt(6)
    v_mfma_f32_32x32x16_bf16 v[128:143], v[40:43], a[40:43], v[128:143]
    ds_read_b64_tr_b16 v[32:33], v244 offset:16384
    ds_read_b64_tr_b16 v[34:35], v244 offset:17408
    ds_read_b64_tr_b16 v[36:37], v245 offset:16384
    ds_read_b64_tr_b16 v[38:39], v245 offset:17408
    v_mfma_f32_32x32x16_bf16 v[144:159], v[40:43], a[44:47], v[144:159]
    s_add_u32 s6, s6, 1024
    buffer_load_dwordx4 a[112:115], v251, s[16:19], s6 offen sc1
    s_waitcnt lgkmcnt(8)
    v_mfma_f32_32x32x16_bf16 v[160:175], v[44:47], a[40:43], v[160:175]
    v_mfma_f32_32x32x16_bf16 v[176:191], v[44:47], a[44:47], v[176:191]
    buffer_load_dwordx4 a[116:119], v17, s[16:19], s6 offen sc1
    s_waitcnt vmcnt(16)
    s_waitcnt lgkmcnt(6)
    v_mfma_f32_32x32x16_bf16 v[128:143], v[24:27], a[48:51], v[128:143]
    ds_read_b64_tr_b16 v[40:41], v240 offset:8192
    ds_read_b64_tr_b16 v[42:43], v240 offset:9216
    ds_read_b64_tr_b16 v[44:45], v241 offset:8192
    ds_read_b64_tr_b16 v[46:47], v241 offset:9216
    v_mfma_f32_32x32x16_bf16 v[144:159], v[24:27], a[52:55], v[144:159]
    s_add_u32 s6, s6, 1024
    buffer_load_dwordx4 a[120:123], v251, s[16:19], s6 offen sc1
    s_waitcnt lgkmcnt(8)
    v_mfma_f32_32x32x16_bf16 v[160:175], v[28:31], a[48:51], v[160:175]
    v_mfma_f32_32x32x16_bf16 v[176:191], v[28:31], a[52:55], v[176:191]
    buffer_load_dwordx4 a[124:127], v17, s[16:19], s6 offen sc1
    s_waitcnt vmcnt(16)
    s_waitcnt lgkmcnt(6)
    v_mfma_f32_32x32x16_bf16 v[128:143], v[32:35], a[56:59], v[128:143]
    ds_read_b64_tr_b16 v[24:25], v240 offset:16384
    ds_read_b64_tr_b16 v[26:27], v240 offset:17408
    ds_read_b64_tr_b16 v[28:29], v241 offset:16384
    ds_read_b64_tr_b16 v[30:31], v241 offset:17408
    v_mfma_f32_32x32x16_bf16 v[144:159], v[32:35], a[60:63], v[144:159]
    s_waitcnt lgkmcnt(8)
    v_mfma_f32_32x32x16_bf16 v[160:175], v[36:39], a[56:59], v[160:175]
    v_mfma_f32_32x32x16_bf16 v[176:191], v[36:39], a[60:63], v[176:191]
    s_waitcnt vmcnt(14)
    s_waitcnt lgkmcnt(6)
    v_mfma_f32_32x32x16_bf16 v[128:143], v[40:43], a[64:67], v[128:143]
    ds_read_b64_tr_b16 v[32:33], v240 offset:57344
    ds_read_b64_tr_b16 v[34:35], v240 offset:58368
    ds_read_b64_tr_b16 v[36:37], v241 offset:57344
    ds_read_b64_tr_b16 v[38:39], v241 offset:58368
    v_mfma_f32_32x32x16_bf16 v[144:159], v[40:43], a[68:71], v[144:159]
    s_waitcnt lgkmcnt(8)
    v_mfma_f32_32x32x16_bf16 v[160:175], v[44:47], a[64:67], v[160:175]
    v_mfma_f32_32x32x16_bf16 v[176:191], v[44:47], a[68:71], v[176:191]
    s_waitcnt vmcnt(12)
    s_waitcnt lgkmcnt(6)
    v_mfma_f32_32x32x16_bf16 v[128:143], v[24:27], a[72:75], v[128:143]
    ds_read_b64_tr_b16 v[40:41], v242 offset:0
    ds_read_b64_tr_b16 v[42:43], v242 offset:1024
    ds_read_b64_tr_b16 v[44:45], v243 offset:0
    ds_read_b64_tr_b16 v[46:47], v243 offset:1024
    v_mfma_f32_32x32x16_bf16 v[144:159], v[24:27], a[76:79], v[144:159]
    s_waitcnt lgkmcnt(8)
    v_mfma_f32_32x32x16_bf16 v[160:175], v[28:31], a[72:75], v[160:175]
    v_mfma_f32_32x32x16_bf16 v[176:191], v[28:31], a[76:79], v[176:191]
    buffer_load_dwordx4 v[72:75], v10, s[12:15], s46 offen sc1
    buffer_load_dwordx4 v[76:79], v10, s[12:15], s46 offen offset:32 sc1
    s_waitcnt vmcnt(12)
    s_waitcnt lgkmcnt(6)
    v_mfma_f32_32x32x16_bf16 v[128:143], v[32:35], a[80:83], v[128:143]
    ds_read_b64_tr_b16 v[24:25], v240 offset:24576
    ds_read_b64_tr_b16 v[26:27], v240 offset:25600
    ds_read_b64_tr_b16 v[28:29], v241 offset:24576
    ds_read_b64_tr_b16 v[30:31], v241 offset:25600
    v_mfma_f32_32x32x16_bf16 v[144:159], v[32:35], a[84:87], v[144:159]
    s_waitcnt lgkmcnt(8)
    v_mfma_f32_32x32x16_bf16 v[160:175], v[36:39], a[80:83], v[160:175]
    v_mfma_f32_32x32x16_bf16 v[176:191], v[36:39], a[84:87], v[176:191]
    s_waitcnt vmcnt(10)
    s_waitcnt lgkmcnt(6)
    v_mfma_f32_32x32x16_bf16 v[128:143], v[40:43], a[88:91], v[128:143]
    ds_read_b64_tr_b16 v[32:33], v240 offset:32768
    ds_read_b64_tr_b16 v[34:35], v240 offset:33792
    ds_read_b64_tr_b16 v[36:37], v241 offset:32768
    ds_read_b64_tr_b16 v[38:39], v241 offset:33792
    v_mfma_f32_32x32x16_bf16 v[144:159], v[40:43], a[92:95], v[144:159]
    s_waitcnt lgkmcnt(8)
    v_mfma_f32_32x32x16_bf16 v[160:175], v[44:47], a[88:91], v[160:175]
    v_mfma_f32_32x32x16_bf16 v[176:191], v[44:47], a[92:95], v[176:191]
    s_waitcnt vmcnt(8)
    s_waitcnt lgkmcnt(6)
    v_mfma_f32_32x32x16_bf16 v[128:143], v[24:27], a[96:99], v[128:143]
    ds_read_b64_tr_b16 v[40:41], v242 offset:8192
    ds_read_b64_tr_b16 v[42:43], v242 offset:9216
    ds_read_b64_tr_b16 v[44:45], v243 offset:8192
    ds_read_b64_tr_b16 v[46:47], v243 offset:9216
    v_mfma_f32_32x32x16_bf16 v[144:159], v[24:27], a[100:103], v[144:159]
    s_waitcnt lgkmcnt(8)
    v_mfma_f32_32x32x16_bf16 v[160:175], v[28:31], a[96:99], v[160:175]
    v_mfma_f32_32x32x16_bf16 v[176:191], v[28:31], a[100:103], v[176:191]
    s_waitcnt vmcnt(6)
    s_waitcnt lgkmcnt(6)
    v_mfma_f32_32x32x16_bf16 v[128:143], v[32:35], a[104:107], v[128:143]
    ds_read_b64_tr_b16 v[24:25], v242 offset:16384
    ds_read_b64_tr_b16 v[26:27], v242 offset:17408
    ds_read_b64_tr_b16 v[28:29], v243 offset:16384
    ds_read_b64_tr_b16 v[30:31], v243 offset:17408
    v_mfma_f32_32x32x16_bf16 v[144:159], v[32:35], a[108:111], v[144:159]
    s_waitcnt lgkmcnt(8)
    v_mfma_f32_32x32x16_bf16 v[160:175], v[36:39], a[104:107], v[160:175]
    v_mfma_f32_32x32x16_bf16 v[176:191], v[36:39], a[108:111], v[176:191]
    s_waitcnt vmcnt(4)
    s_waitcnt lgkmcnt(6)
    v_mfma_f32_32x32x16_bf16 v[128:143], v[40:43], a[112:115], v[128:143]
    v_mfma_f32_32x32x16_bf16 v[144:159], v[40:43], a[116:119], v[144:159]
    s_waitcnt lgkmcnt(4)
    v_mfma_f32_32x32x16_bf16 v[160:175], v[44:47], a[112:115], v[160:175]
    v_mfma_f32_32x32x16_bf16 v[176:191], v[44:47], a[116:119], v[176:191]
    s_waitcnt vmcnt(2)
    s_waitcnt lgkmcnt(2)
    v_mfma_f32_32x32x16_bf16 v[128:143], v[24:27], a[120:123], v[128:143]
    v_mfma_f32_32x32x16_bf16 v[144:159], v[24:27], a[124:127], v[144:159]
    s_waitcnt lgkmcnt(0)
    v_mfma_f32_32x32x16_bf16 v[160:175], v[28:31], a[120:123], v[160:175]
    v_mfma_f32_32x32x16_bf16 v[176:191], v[28:31], a[124:127], v[176:191]
    v_add_u32 v4, s26, v15
    v_add_u32 v5, 0x10000, v4
    v_add_u32 v18, 0x20000, v4
    s_nop 7
    ds_write_b128 v5, v[160:163] offset:57344
    ds_write_b128 v5, v[164:167] offset:58368
    ds_write_b128 v18, v[168:171] offset:24576
    ds_write_b128 v18, v[172:175] offset:25600
    ds_write_b128 v4, v[176:179] offset:40960
    ds_write_b128 v4, v[180:183] offset:41984
    ds_write_b128 v5, v[184:187] offset:24576
    ds_write_b128 v5, v[188:191] offset:25600
    ds_write_b128 v4, v[144:147] offset:0
    ds_write_b128 v4, v[148:151] offset:1024
    ds_write_b128 v4, v[152:155] offset:49152
    ds_write_b128 v4, v[156:159] offset:50176
    s_xor_b32 s6, s26, 2048
    s_add_u32 s7, s6, 155648
    s_add_u32 s6, s6, 122880
    v_add_u32 v90, s6, v15
    v_add_u32 v91, s7, v15
    s_xor_b32 s6, s26, 4096
    s_add_u32 s7, s6, 49152
    s_add_u32 s6, s6, 0
    v_add_u32 v92, s6, v15
    v_add_u32 v93, s7, v15
    s_xor_b32 s6, s26, 6144
    s_add_u32 s7, s6, 90112
    s_add_u32 s6, s6, 40960
    v_add_u32 v94, s6, v15
    v_add_u32 v95, s7, v15
    s_waitcnt vmcnt(0)
    v_lshlrev_b32 v96, 16, v124
    v_and_b32 v97, s40, v124
    v_lshlrev_b32 v98, 16, v125
    v_and_b32 v99, s40, v125
    v_lshlrev_b32 v100, 16, v126
    v_and_b32 v101, s40, v126
    v_lshlrev_b32 v102, 16, v127
    v_and_b32 v103, s40, v127
    v_lshlrev_b32 v104, 16, v116
    v_and_b32 v105, s40, v116
    v_lshlrev_b32 v106, 16, v117
    v_and_b32 v107, s40, v117
    v_lshlrev_b32 v108, 16, v118
    v_and_b32 v109, s40, v118
    v_lshlrev_b32 v110, 16, v119
    v_and_b32 v111, s40, v119
    v_lshlrev_b32 v48, 16, v72
    v_and_b32 v49, s40, v72
    v_lshlrev_b32 v50, 16, v73
    v_and_b32 v51, s40, v73
    v_lshlrev_b32 v52, 16, v74
    v_and_b32 v53, s40, v74
    v_lshlrev_b32 v54, 16, v75
    v_and_b32 v55, s40, v75
    v_lshlrev_b32 v56, 16, v76
    v_and_b32 v57, s40, v76
    v_lshlrev_b32 v58, 16, v77
    v_and_b32 v59, s40, v77
    v_lshlrev_b32 v60, 16, v78
    v_and_b32 v61, s40, v78
    v_lshlrev_b32 v62, 16, v79
    v_and_b32 v63, s40, v79
    s_waitcnt lgkmcnt(0)
    s_barrier
    ds_read_b128 v[144:147], v90 offset:0
    ds_read_b128 v[148:151], v90 offset:1024
    ds_read_b128 v[152:155], v91 offset:0
    ds_read_b128 v[156:159], v91 offset:1024
    ds_read_b128 v[160:163], v92 offset:0
    ds_read_b128 v[164:167], v92 offset:1024
    ds_read_b128 v[168:171], v93 offset:0
    ds_read_b128 v[172:175], v93 offset:1024
    ds_read_b128 v[176:179], v94 offset:0
    ds_read_b128 v[180:183], v94 offset:1024
    ds_read_b128 v[184:187], v95 offset:0
    ds_read_b128 v[188:191], v95 offset:1024
    s_waitcnt lgkmcnt(8)
    v_pk_add_f32 v[128:129], v[128:129], v[144:145]
    v_pk_add_f32 v[130:131], v[130:131], v[146:147]
    v_pk_add_f32 v[132:133], v[132:133], v[148:149]
    v_pk_add_f32 v[134:135], v[134:135], v[150:151]
    v_pk_add_f32 v[136:137], v[136:137], v[152:153]
    v_pk_add_f32 v[138:139], v[138:139], v[154:155]
    v_pk_add_f32 v[140:141], v[140:141], v[156:157]
    v_pk_add_f32 v[142:143], v[142:143], v[158:159]
    s_waitcnt lgkmcnt(4)
    v_pk_add_f32 v[128:129], v[128:129], v[160:161]
    v_pk_add_f32 v[130:131], v[130:131], v[162:163]
    v_pk_add_f32 v[132:133], v[132:133], v[164:165]
    v_pk_add_f32 v[134:135], v[134:135], v[166:167]
    v_pk_add_f32 v[136:137], v[136:137], v[168:169]
    v_pk_add_f32 v[138:139], v[138:139], v[170:171]
    v_pk_add_f32 v[140:141], v[140:141], v[172:173]
    v_pk_add_f32 v[142:143], v[142:143], v[174:175]
    s_waitcnt lgkmcnt(0)
    v_pk_add_f32 v[128:129], v[128:129], v[176:177]
    v_pk_add_f32 v[130:131], v[130:131], v[178:179]
    v_pk_add_f32 v[132:133], v[132:133], v[180:181]
    v_pk_add_f32 v[134:135], v[134:135], v[182:183]
    v_pk_add_f32 v[136:137], v[136:137], v[184:185]
    v_pk_add_f32 v[138:139], v[138:139], v[186:187]
    v_pk_add_f32 v[140:141], v[140:141], v[188:189]
    v_pk_add_f32 v[142:143], v[142:143], v[190:191]
    v_permlane32_swap_b32 v128, v132
    v_permlane32_swap_b32 v129, v133
    v_permlane32_swap_b32 v130, v134
    v_permlane32_swap_b32 v131, v135
    v_pk_fma_f32 v[128:129], v[128:129], v[96:97], v[48:49]
    v_pk_fma_f32 v[130:131], v[130:131], v[98:99], v[50:51]
    v_pk_fma_f32 v[132:133], v[132:133], v[100:101], v[52:53]
    v_pk_fma_f32 v[134:135], v[134:135], v[102:103], v[54:55]
    v_cvt_pk_bf16_f32 v40, v128, v129
    v_cvt_pk_bf16_f32 v41, v130, v131
    v_cvt_pk_bf16_f32 v42, v132, v133
    v_cvt_pk_bf16_f32 v43, v134, v135
    buffer_store_dwordx4 v[40:43], v10, s[12:15], s39 offen offset:0
    v_permlane32_swap_b32 v136, v140
    v_permlane32_swap_b32 v137, v141
    v_permlane32_swap_b32 v138, v142
    v_permlane32_swap_b32 v139, v143
    v_pk_fma_f32 v[136:137], v[136:137], v[104:105], v[56:57]
    v_pk_fma_f32 v[138:139], v[138:139], v[106:107], v[58:59]
    v_pk_fma_f32 v[140:141], v[140:141], v[108:109], v[60:61]
    v_pk_fma_f32 v[142:143], v[142:143], v[110:111], v[62:63]
    v_cvt_pk_bf16_f32 v44, v136, v137
    v_cvt_pk_bf16_f32 v45, v138, v139
    v_cvt_pk_bf16_f32 v46, v140, v141
    v_cvt_pk_bf16_f32 v47, v142, v143
    buffer_store_dwordx4 v[44:47], v10, s[12:15], s39 offen offset:32
    s_or_b32 s4, s2, s3
    s_cmp_lg_u32 s4, 0
    s_cbranch_scc1 L_noep
    s_mov_b32 s4, 0x1408000
    s_mov_b64 exec, 0x1
    buffer_store_dword v20, v21, s[16:19], s4 offen
    s_mov_b64 exec, -1
L_noep:
L_end:
L_last:
    s_endpgm
.section .rodata,"a"
.p2align 6
.amdhsa_kernel adaLN_cond__ssm_conv_h3__geglu_ffn__prompt_kernel
  .amdhsa_next_free_vgpr 512
  .amdhsa_next_free_sgpr 102
  .amdhsa_accum_offset 256
  .amdhsa_group_segment_fixed_size 0
  .amdhsa_kernarg_size 120
  .amdhsa_user_sgpr_count 2
  .amdhsa_user_sgpr_kernarg_segment_ptr 1
  .amdhsa_system_sgpr_workgroup_id_x 1
.end_amdhsa_kernel
```
